```python
import torch

def _softmax(x, axis=-1):
    return torch.softmax(x, dim=axis)
def _gelu(x):
    return torch.nn.functional.gelu(x, approximate="tanh")
def _silu(x):
    return torch.nn.functional.silu(x)
def _sigmoid(x):
    return torch.sigmoid(x)
def _layernorm(x, axis=-1, eps=1e-5):
    m = x.mean(dim=axis, keepdim=True)
    v = x.var(dim=axis, keepdim=True, unbiased=False)
    return (x - m) / torch.sqrt(v + eps)
def _scatter_add(tgt, idx, src, axis=0):
    return tgt.clone().index_add_(axis, idx, src)
def _segment_sum(src, seg, n):
    out = torch.zeros((n,) + src.shape[1:], dtype=src.dtype)
    return out.index_add_(0, seg, src)
def _pad(x, pw):
    flat = tuple(v for pair in reversed(pw) for v in pair)
    return torch.nn.functional.pad(x, flat)

kernel_name = 'gated_mix__ssm_conv_s4__glu_gated_geglu__prompt'

def setup_inputs():

    _w = (lambda a: (lambda t: t.to(torch.bfloat16) if t.is_floating_point() else t)(torch.as_tensor(a)))
    def _A_setup():
        B, L, D, N = 1, 2048, 448, 256
        A_re = -(lambda _x: torch.exp(torch.as_tensor(_x)))((lambda *s: torch.randn(*s, dtype=torch.bfloat16) * 6.4)(D, N))
        A_im = torch.pi * (lambda *s: torch.randn(*s, dtype=torch.bfloat16) * 0.05)(D, N)
        B_re = (lambda *s: torch.randn(*s, dtype=torch.bfloat16) * 0.05)(D, N)
        B_im = (lambda *s: torch.randn(*s, dtype=torch.bfloat16) * 0.05)(D, N)
        C_re = (lambda *s: torch.randn(*s, dtype=torch.bfloat16) * 0.05)(D, N)
        C_im = (lambda *s: torch.randn(*s, dtype=torch.bfloat16) * 0.05)(D, N)
        log_dt = (lambda *s: torch.randn(*s, dtype=torch.bfloat16) * 0.05)(D) * 0.5 - 4.0
        Dskip = (lambda *s: torch.randn(*s, dtype=torch.bfloat16) * 0.05)(D)
        return {
            "u": _w((lambda *s: torch.randn(*s, dtype=torch.bfloat16) * 0.05)(B, L, D)),
            "A_re": _w(A_re),
            "A_im": _w(A_im),
            "B_re": _w(B_re),
            "B_im": _w(B_im),
            "C_re": _w(C_re),
            "C_im": _w(C_im),
            "log_dt": _w(log_dt),
            "Dskip": _w(Dskip),
        }
    _A_in = _A_setup()

    def _B_setup():
        B, S, Dm, Df = 1, 2048, 448, 1792
        return {
            "x": _w((lambda *s: torch.randn(*s, dtype=torch.bfloat16) * 0.05)(B, S, Dm)),
            "w_gate": _w((lambda *s: torch.randn(*s, dtype=torch.bfloat16) * 1.6)(Dm, Df) * (Dm ** -0.5)),
            "w_up": _w((lambda *s: torch.randn(*s, dtype=torch.bfloat16) * 1.6)(Dm, Df) * (Dm ** -0.5)),
            "w_down": _w((lambda *s: torch.randn(*s, dtype=torch.bfloat16) * 1.6)(Df, Dm) * (Df ** -0.5)),
        }
    _B_in = _B_setup()

    return {
        "A_u": _A_in["u"],
        "A_A_re": _A_in["A_re"],
        "A_A_im": _A_in["A_im"],
        "A_B_re": _A_in["B_re"],
        "A_B_im": _A_in["B_im"],
        "A_C_re": _A_in["C_re"],
        "A_C_im": _A_in["C_im"],
        "A_log_dt": _A_in["log_dt"],
        "A_Dskip": _A_in["Dskip"],
        "B_x": _B_in["x"],
        "B_w_gate": _B_in["w_gate"],
        "B_w_up": _B_in["w_up"],
        "B_w_down": _B_in["w_down"],
        "gate_w": _w((lambda *s: torch.randn(*s, dtype=torch.bfloat16) * 0.05)(448) * 16.0),
    }

def reference(A_u, A_A_re, A_A_im, A_B_re, A_B_im, A_C_re, A_C_im, A_log_dt, A_Dskip, B_x, B_w_gate, B_w_up, B_w_down, gate_w):
    def _A_ref(u, A_re, A_im, B_re, B_im, C_re, C_im, log_dt, Dskip):
        Bsz, L, D = u.shape
        dt = torch.exp(log_dt)[:, None]
        A = A_re + 1j * A_im
        Bc = B_re + 1j * B_im
        Cc = C_re + 1j * C_im
        logdA = dt * A
        dB = dt * Bc
        l = (lambda x, dt: x.to(dt))(torch.arange(L), A_re.dtype)
        P = torch.exp(logdA[:, :, None] * l[None, None, :])
        K = torch.einsum("dn,dnl,dn->dl", Cc, P, dB).real
        L2 = 2 * L
        Kp = _pad(K, ((0, 0), (0, L)))
        up = (lambda x, *d: x.permute(*d))(u, 0, 2, 1)
        up = _pad(up, ((0, 0), (0, 0), (0, L)))
        Kf = (lambda x, axes=(-2,-1): torch.fft.rfft2(x.float(), dim=axes))(Kp[:, None, :], axes=(-2, -1))
        Uf = (lambda x, axes=(-2,-1): torch.fft.rfft2(x.float(), dim=axes))(up[:, :, None, :], axes=(-2, -1))
        Yf = Uf * Kf[None, :, :, :]
        y = (lambda x, s, axes=(-2,-1): torch.fft.irfft2(x, s=s, dim=axes).to(torch.bfloat16))(Yf, (1, L2), axes=(-2, -1))[:, :, 0, :L]
        y = (lambda x, *d: x.permute(*d))(y, 0, 2, 1) + u * Dskip[None, None, :]
        return y

    def _B_ref(x, w_gate, w_up, w_down):
        g = torch.einsum("bsd,df->bsf", x, w_gate)
        u = torch.einsum("bsd,df->bsf", x, w_up)
        h = _gelu(g) * u
        return torch.einsum("bsf,fd->bsd", h, w_down)

    x = A_u
    g = _sigmoid((x * gate_w).sum(-1, keepdims=True))
    a = _A_ref(x, A_A_re, A_A_im, A_B_re, A_B_im, A_C_re, A_C_im, A_log_dt, A_Dskip)
    b = _B_ref(x, B_w_gate, B_w_up, B_w_down)
    return g * a + (1 - g) * b
```

```asm
; @launch grid=(448,1,1) block=(256,1,1) lds=81920
.amdgcn_target "amdgcn-amd-amdhsa--gfx950"
.text
.globl gated_mix__ssm_conv_s4__glu_gated_geglu__prompt_kernel
.p2align 8
.type gated_mix__ssm_conv_s4__glu_gated_geglu__prompt_kernel,@function
gated_mix__ssm_conv_s4__glu_gated_geglu__prompt_kernel:
    s_cmp_ge_u32 s2, 448
    s_cbranch_scc1 K_exit
    s_and_b32 s3, s2, 7
    s_lshr_b32 s33, s2, 3
    s_getpc_b64 s[4:5]
K_pc:
    s_mul_i32 s6, s33, 5
    v_add_u32 v1, s6, v0
    v_lshlrev_b32 v1, 7, v1
    v_min_u32 v1, K_exit - K_pc, v1
    v_cmp_gt_u32 vcc, 5, v0
    s_and_saveexec_b64 s[6:7], vcc
    s_cbranch_execz K_nopf
    global_load_dword v63, v1, s[4:5]
K_nopf:
    s_mov_b64 exec, s[6:7]
    s_cmp_ge_u32 s33, 28
    s_cbranch_scc1 K_s
    s_lshr_b32 s25, s3, 1
    s_lshl_b32 s25, s25, 2
    s_and_b32 s26, s33, 3
    s_add_u32 s25, s25, s26
    s_and_b32 s26, s3, 1
    s_mul_i32 s26, s26, 7
    s_lshr_b32 s33, s33, 2
    s_add_u32 s26, s26, s33
    s_load_dwordx2 s[4:5], s[0:1], 0
    s_load_dwordx4 s[28:31], s[0:1], 80
    s_load_dwordx2 s[6:7], s[0:1], 128
    s_load_dwordx2 s[48:49], s[0:1], 96
    s_load_dwordx4 s[52:55], s[0:1], 112
    s_setprio 1
    v_lshrrev_b32 v13, 6, v0
    v_and_b32 v0, 63, v0
    v_readfirstlane_b32 s24, v13
    v_lshrrev_b32 v14, 3, v0
    v_lshrrev_b32 v15, 4, v0
    s_and_b32 s27, s24, 1
    s_lshr_b32 s32, s24, 1
    s_lshl_b32 s33, s27, 2
    v_add_u32 v16, s33, v15
    v_and_b32 v17, 7, v0
    v_xor_b32 v17, v17, v16
    v_lshlrev_b32 v17, 4, v17
    v_mov_b32 v18, 896
    v_mad_u32_u24 v1, v14, v18, v17
    v_lshlrev_b32 v16, 1, v15
    v_and_b32 v17, 15, v0
    v_xor_b32 v17, v17, v16
    v_lshlrev_b32 v17, 4, v17
    v_mov_b32 v18, 3584
    v_mad_u32_u24 v2, v15, v18, v17
    v_xor_b32 v3, 128, v2
    s_lshl_b32 s34, s25, 4
    s_add_u32 s34, s34, s24
    s_mul_i32 s34, s34, 7168
    s_mul_i32 s35, s24, 14336
    s_lshl_b32 s37, s26, 8
    s_add_u32 s35, s35, s37
    s_lshl_b32 s36, s24, 10
    s_and_b32 s85, s25, 3
    v_bfe_u32 v19, v0, 1, 3
    v_lshl_add_u32 v19, v15, 5, v19
    s_lshl_b32 s38, s85, 3
    v_add_u32 v19, s38, v19
    v_mul_u32_u24 v19, 3584, v19
    v_and_b32 v20, 1, v0
    v_lshl_add_u32 v19, v20, 7, v19
    v_add_u32 v22, s37, v19
    v_and_b32 v19, 31, v0
    v_min_u32 v19, 18, v19
    s_cmp_ge_u32 s26, 7
    s_cselect_b32 s38, 7, 0
    s_sub_u32 s38, s26, s38
    s_lshl_b32 s85, s85, 1
    s_add_u32 s85, s85, s38
    s_cmp_ge_u32 s85, 7
    s_cselect_b32 s86, 7, 0
    s_sub_u32 s85, s85, s86
    s_mov_b32 s60, 0
    s_mov_b32 s62, s60
    s_mul_i32 s38, s38, 19
    v_add_u32 v19, s38, v19
    v_min_u32 v19, 127, v19
    s_lshl_b32 s38, s25, 7
    v_add_u32 v19, s38, v19
    v_mul_u32_u24 v19, 896, v19
    v_lshrrev_b32 v20, 5, v0
    v_lshl_add_u32 v23, v20, 7, v19
    s_waitcnt lgkmcnt(0)
    s_mov_b32 s8, s4
    s_mov_b32 s9, s5
    s_mov_b32 s10, 1835008
    s_mov_b32 s11, 0x00020000
    s_mov_b32 s12, s28
    s_mov_b32 s13, s29
    s_mov_b32 s14, 1605632
    s_mov_b32 s15, 0x00020000
    s_mov_b32 s16, s30
    s_mov_b32 s17, s31
    s_mov_b32 s18, 1605632
    s_mov_b32 s19, 0x00020000
    s_mov_b32 s44, s54
    s_mov_b32 s45, s55
    s_mov_b32 s46, 256
    s_mov_b32 s47, 0x00020000
    s_xor_b32 s33, s24, 3
    s_or_b32 s33, s2, s33
    s_cmp_lg_u32 s33, 0
    s_cbranch_scc1 FG_notag
    s_memrealtime s[40:41]
    v_mov_b32 v28, 0
    s_waitcnt lgkmcnt(0)
    s_or_b32 s40, s40, 1
    v_mov_b32 v26, s40
    v_mov_b32 v27, s41
    s_mov_b64 exec, 1
    buffer_store_dwordx2 v[26:27], v28, s[44:47], 0 offen sc1
    s_mov_b64 exec, -1
FG_notag:
    s_lshl_b32 s61, s60, 7
    s_add_u32 s61, s61, s34
    s_add_u32 s60, s60, 1
    s_cmp_eq_u32 s60, 7
    s_cselect_b32 s60, 0, s60
    s_add_u32 m0, s36, 49152
    s_add_u32 s38, s61, 0
    buffer_load_dwordx4 v1, s[8:11], s38 offen lds
    s_add_u32 m0, s36, 53248
    s_add_u32 s38, s61, 28672
    buffer_load_dwordx4 v1, s[8:11], s38 offen lds
    s_add_u32 m0, s36, 57344
    s_add_u32 s38, s61, 57344
    buffer_load_dwordx4 v1, s[8:11], s38 offen lds
    s_add_u32 m0, s36, 61440
    s_add_u32 s38, s61, 86016
    buffer_load_dwordx4 v1, s[8:11], s38 offen lds
    s_mul_i32 s63, s62, 229376
    s_add_u32 s63, s63, s35
    s_add_u32 s62, s62, 1
    s_cmp_eq_u32 s62, 7
    s_cselect_b32 s62, 0, s62
    s_add_u32 m0, s36, 0
    s_add_u32 s38, s63, 0
    buffer_load_dwordx4 v2, s[12:15], s38 offen lds
    s_add_u32 m0, s36, 8192
    s_add_u32 s38, s63, 0
    buffer_load_dwordx4 v3, s[16:19], s38 offen lds
    s_add_u32 m0, s36, 4096
    s_add_u32 s38, s63, 57344
    buffer_load_dwordx4 v2, s[12:15], s38 offen lds
    s_add_u32 m0, s36, 12288
    s_add_u32 s38, s63, 57344
    buffer_load_dwordx4 v3, s[16:19], s38 offen lds
    s_add_u32 m0, s36, 16384
    s_add_u32 s38, s63, 114688
    buffer_load_dwordx4 v2, s[12:15], s38 offen lds
    s_add_u32 m0, s36, 24576
    s_add_u32 s38, s63, 114688
    buffer_load_dwordx4 v3, s[16:19], s38 offen lds
    s_add_u32 m0, s36, 20480
    s_add_u32 s38, s63, 172032
    buffer_load_dwordx4 v2, s[12:15], s38 offen lds
    s_add_u32 m0, s36, 28672
    s_add_u32 s38, s63, 172032
    buffer_load_dwordx4 v3, s[16:19], s38 offen lds
    s_lshl_b32 s61, s60, 7
    s_add_u32 s61, s61, s34
    s_add_u32 s60, s60, 1
    s_cmp_eq_u32 s60, 7
    s_cselect_b32 s60, 0, s60
    s_add_u32 m0, s36, 65536
    s_add_u32 s38, s61, 0
    buffer_load_dwordx4 v1, s[8:11], s38 offen lds
    s_add_u32 m0, s36, 69632
    s_add_u32 s38, s61, 28672
    buffer_load_dwordx4 v1, s[8:11], s38 offen lds
    s_add_u32 m0, s36, 73728
    s_add_u32 s38, s61, 57344
    buffer_load_dwordx4 v1, s[8:11], s38 offen lds
    s_add_u32 m0, s36, 77824
    s_add_u32 s38, s61, 86016
    buffer_load_dwordx4 v1, s[8:11], s38 offen lds
    s_mul_i32 s63, s62, 229376
    s_add_u32 s63, s63, s35
    s_add_u32 s62, s62, 1
    s_cmp_eq_u32 s62, 7
    s_cselect_b32 s62, 0, s62
    s_add_u32 m0, s36, 32768
    s_add_u32 s38, s63, 0
    buffer_load_dwordx4 v2, s[12:15], s38 offen lds
    s_add_u32 m0, s36, 40960
    s_add_u32 s38, s63, 0
    buffer_load_dwordx4 v3, s[16:19], s38 offen lds
    s_add_u32 m0, s36, 36864
    s_add_u32 s38, s63, 57344
    buffer_load_dwordx4 v2, s[12:15], s38 offen lds
    s_add_u32 m0, s36, 45056
    s_add_u32 s38, s63, 57344
    buffer_load_dwordx4 v3, s[16:19], s38 offen lds
    s_mov_b32 s20, s6
    s_mov_b32 s21, s7
    s_mov_b32 s22, 7340032
    s_mov_b32 s23, 0x00020000
    s_add_u32 s56, s6, 13107200
    s_addc_u32 s57, s7, 0
    s_mov_b32 s58, 30720
    s_mov_b32 s59, 0x00020000
    v_and_b32 v16, 31, v0
    v_lshrrev_b32 v17, 5, v0
    v_bfe_u32 v18, v0, 1, 3
    s_lshl_b32 s33, s27, 13
    s_add_u32 s33, s33, 49152
    v_lshlrev_b32 v16, 7, v16
    v_add_u32 v16, s33, v16
    v_or_b32 v19, 0, v17
    v_xor_b32 v19, v19, v18
    v_lshl_add_u32 v4, v19, 4, v16
    v_or_b32 v19, 2, v17
    v_xor_b32 v19, v19, v18
    v_lshl_add_u32 v5, v19, 4, v16
    v_or_b32 v19, 4, v17
    v_xor_b32 v19, v19, v18
    v_lshl_add_u32 v6, v19, 4, v16
    v_or_b32 v19, 6, v17
    v_xor_b32 v19, v19, v18
    v_lshl_add_u32 v7, v19, 4, v16
    v_bfe_u32 v16, v0, 4, 1
    v_bfe_u32 v18, v0, 2, 2
    v_and_b32 v19, 3, v0
    v_lshlrev_b32 v20, 13, v16
    v_lshl_add_u32 v20, v17, 11, v20
    v_lshl_add_u32 v20, v18, 8, v20
    v_lshl_add_u32 v20, v19, 3, v20
    v_lshl_or_b32 v21, v16, 2, v18
    s_lshl_b32 s33, s32, 2
    v_xor_b32 v21, s33, v21
    v_xor_b32 v19, 0, v21
    v_lshl_add_u32 v8, v19, 5, v20
    v_xor_b32 v19, 1, v21
    v_lshl_add_u32 v9, v19, 5, v20
    v_xor_b32 v19, 2, v21
    v_lshl_add_u32 v10, v19, 5, v20
    v_xor_b32 v19, 3, v21
    v_lshl_add_u32 v11, v19, 5, v20
    s_lshl_b32 s33, s25, 1
    s_add_u32 s33, s33, s27
    s_mul_i32 s33, s33, 224
    s_lshl_b32 s37, s26, 3
    s_add_u32 s33, s33, s37
    s_lshl_b32 s37, s32, 2
    s_add_u32 s33, s33, s37
    s_lshl_b32 s39, s33, 10
    v_lshlrev_b32 v12, 4, v0
    s_waitcnt vmcnt(12)
    s_barrier
    ds_read_b128 v[16:19], v4 offset:0
    ds_read_b64_tr_b16 v[24:25], v8 offset:0
    ds_read_b64_tr_b16 v[26:27], v8 offset:1024
    ds_read_b128 v[20:23], v4 offset:4096
    ds_read_b64_tr_b16 v[28:29], v9 offset:0
    ds_read_b64_tr_b16 v[30:31], v9 offset:1024
    ds_read_b64_tr_b16 v[32:33], v10 offset:0
    ds_read_b64_tr_b16 v[34:35], v10 offset:1024
    ds_read_b64_tr_b16 v[36:37], v11 offset:0
    ds_read_b64_tr_b16 v[38:39], v11 offset:1024
    s_waitcnt lgkmcnt(0)
    v_mfma_f32_32x32x16_bf16 v[64:79], v[24:27], v[16:19], 0
    ds_read_b128 v[40:43], v5 offset:0
    ds_read_b64_tr_b16 v[48:49], v8 offset:4096
    v_mfma_f32_32x32x16_bf16 v[128:143], v[24:27], v[20:23], 0
    ds_read_b64_tr_b16 v[50:51], v8 offset:5120
    ds_read_b128 v[44:47], v5 offset:4096
    v_mfma_f32_32x32x16_bf16 v[80:95], v[28:31], v[16:19], 0
    ds_read_b64_tr_b16 v[52:53], v9 offset:4096
    ds_read_b64_tr_b16 v[54:55], v9 offset:5120
    v_mfma_f32_32x32x16_bf16 v[144:159], v[28:31], v[20:23], 0
    ds_read_b64_tr_b16 v[56:57], v10 offset:4096
    ds_read_b64_tr_b16 v[58:59], v10 offset:5120
    v_mfma_f32_32x32x16_bf16 v[96:111], v[32:35], v[16:19], 0
    ds_read_b64_tr_b16 v[60:61], v11 offset:4096
    ds_read_b64_tr_b16 v[62:63], v11 offset:5120
    v_mfma_f32_32x32x16_bf16 v[160:175], v[32:35], v[20:23], 0
    v_mfma_f32_32x32x16_bf16 v[112:127], v[36:39], v[16:19], 0
    v_mfma_f32_32x32x16_bf16 v[176:191], v[36:39], v[20:23], 0
    s_waitcnt vmcnt(8) lgkmcnt(0)
    s_barrier
    v_mfma_f32_32x32x16_bf16 v[64:79], v[48:51], v[40:43], v[64:79]
    ds_read_b128 v[16:19], v6 offset:0
    ds_read_b64_tr_b16 v[24:25], v8 offset:16384
    s_add_u32 m0, s36, 0
    s_add_u32 s38, s63, 114688
    buffer_load_dwordx4 v2, s[12:15], s38 offen lds
    v_mfma_f32_32x32x16_bf16 v[128:143], v[48:51], v[44:47], v[128:143]
    ds_read_b64_tr_b16 v[26:27], v8 offset:17408
    ds_read_b128 v[20:23], v6 offset:4096
    s_add_u32 m0, s36, 8192
    s_add_u32 s38, s63, 114688
    buffer_load_dwordx4 v3, s[16:19], s38 offen lds
    v_mfma_f32_32x32x16_bf16 v[80:95], v[52:55], v[40:43], v[80:95]
    ds_read_b64_tr_b16 v[28:29], v9 offset:16384
    ds_read_b64_tr_b16 v[30:31], v9 offset:17408
    s_add_u32 m0, s36, 4096
    s_add_u32 s38, s63, 172032
    buffer_load_dwordx4 v2, s[12:15], s38 offen lds
    v_mfma_f32_32x32x16_bf16 v[144:159], v[52:55], v[44:47], v[144:159]
    ds_read_b64_tr_b16 v[32:33], v10 offset:16384
    ds_read_b64_tr_b16 v[34:35], v10 offset:17408
    s_add_u32 m0, s36, 12288
    s_add_u32 s38, s63, 172032
    buffer_load_dwordx4 v3, s[16:19], s38 offen lds
    v_mfma_f32_32x32x16_bf16 v[96:111], v[56:59], v[40:43], v[96:111]
    ds_read_b64_tr_b16 v[36:37], v11 offset:16384
    ds_read_b64_tr_b16 v[38:39], v11 offset:17408
    v_mfma_f32_32x32x16_bf16 v[160:175], v[56:59], v[44:47], v[160:175]
    v_mfma_f32_32x32x16_bf16 v[112:127], v[60:63], v[40:43], v[112:127]
    v_mfma_f32_32x32x16_bf16 v[176:191], v[60:63], v[44:47], v[176:191]
    s_waitcnt lgkmcnt(0)
    v_mfma_f32_32x32x16_bf16 v[64:79], v[24:27], v[16:19], v[64:79]
    ds_read_b128 v[40:43], v7 offset:0
    ds_read_b64_tr_b16 v[48:49], v8 offset:20480
    v_mfma_f32_32x32x16_bf16 v[128:143], v[24:27], v[20:23], v[128:143]
    ds_read_b64_tr_b16 v[50:51], v8 offset:21504
    ds_read_b128 v[44:47], v7 offset:4096
    v_mfma_f32_32x32x16_bf16 v[80:95], v[28:31], v[16:19], v[80:95]
    ds_read_b64_tr_b16 v[52:53], v9 offset:20480
    ds_read_b64_tr_b16 v[54:55], v9 offset:21504
    v_mfma_f32_32x32x16_bf16 v[144:159], v[28:31], v[20:23], v[144:159]
    ds_read_b64_tr_b16 v[56:57], v10 offset:20480
    ds_read_b64_tr_b16 v[58:59], v10 offset:21504
    v_mfma_f32_32x32x16_bf16 v[96:111], v[32:35], v[16:19], v[96:111]
    ds_read_b64_tr_b16 v[60:61], v11 offset:20480
    ds_read_b64_tr_b16 v[62:63], v11 offset:21504
    v_mfma_f32_32x32x16_bf16 v[160:175], v[32:35], v[20:23], v[160:175]
    v_mfma_f32_32x32x16_bf16 v[112:127], v[36:39], v[16:19], v[112:127]
    v_mfma_f32_32x32x16_bf16 v[176:191], v[36:39], v[20:23], v[176:191]
    s_waitcnt vmcnt(4) lgkmcnt(0)
    s_barrier
    v_mfma_f32_32x32x16_bf16 v[64:79], v[48:51], v[40:43], v[64:79]
    ds_read_b128 v[16:19], v4 offset:16384
    ds_read_b64_tr_b16 v[24:25], v8 offset:32768
    s_mul_i32 s63, s62, 229376
    s_add_u32 s63, s63, s35
    s_add_u32 s62, s62, 1
    s_cmp_eq_u32 s62, 7
    s_cselect_b32 s62, 0, s62
    s_add_u32 m0, s36, 16384
    s_add_u32 s38, s63, 0
    buffer_load_dwordx4 v2, s[12:15], s38 offen lds
    v_mfma_f32_32x32x16_bf16 v[128:143], v[48:51], v[44:47], v[128:143]
    ds_read_b64_tr_b16 v[26:27], v8 offset:33792
    ds_read_b128 v[20:23], v4 offset:20480
    s_add_u32 m0, s36, 24576
    s_add_u32 s38, s63, 0
    buffer_load_dwordx4 v3, s[16:19], s38 offen lds
    v_mfma_f32_32x32x16_bf16 v[80:95], v[52:55], v[40:43], v[80:95]
    ds_read_b64_tr_b16 v[28:29], v9 offset:32768
    ds_read_b64_tr_b16 v[30:31], v9 offset:33792
    s_add_u32 m0, s36, 20480
    s_add_u32 s38, s63, 57344
    buffer_load_dwordx4 v2, s[12:15], s38 offen lds
    v_mfma_f32_32x32x16_bf16 v[144:159], v[52:55], v[44:47], v[144:159]
    ds_read_b64_tr_b16 v[32:33], v10 offset:32768
    ds_read_b64_tr_b16 v[34:35], v10 offset:33792
    s_add_u32 m0, s36, 28672
    s_add_u32 s38, s63, 57344
    buffer_load_dwordx4 v3, s[16:19], s38 offen lds
    v_mfma_f32_32x32x16_bf16 v[96:111], v[56:59], v[40:43], v[96:111]
    ds_read_b64_tr_b16 v[36:37], v11 offset:32768
    ds_read_b64_tr_b16 v[38:39], v11 offset:33792
    s_lshl_b32 s61, s60, 7
    s_add_u32 s61, s61, s34
    s_add_u32 s60, s60, 1
    s_cmp_eq_u32 s60, 7
    s_cselect_b32 s60, 0, s60
    s_add_u32 m0, s36, 49152
    s_add_u32 s38, s61, 0
    buffer_load_dwordx4 v1, s[8:11], s38 offen lds
    v_mfma_f32_32x32x16_bf16 v[160:175], v[56:59], v[44:47], v[160:175]
    s_add_u32 m0, s36, 53248
    s_add_u32 s38, s61, 28672
    buffer_load_dwordx4 v1, s[8:11], s38 offen lds
    v_mfma_f32_32x32x16_bf16 v[112:127], v[60:63], v[40:43], v[112:127]
    s_add_u32 m0, s36, 57344
    s_add_u32 s38, s61, 57344
    buffer_load_dwordx4 v1, s[8:11], s38 offen lds
    v_mfma_f32_32x32x16_bf16 v[176:191], v[60:63], v[44:47], v[176:191]
    s_add_u32 m0, s36, 61440
    s_add_u32 s38, s61, 86016
    buffer_load_dwordx4 v1, s[8:11], s38 offen lds
    s_waitcnt lgkmcnt(0)
    v_mfma_f32_32x32x16_bf16 v[64:79], v[24:27], v[16:19], v[64:79]
    ds_read_b128 v[40:43], v5 offset:16384
    ds_read_b64_tr_b16 v[48:49], v8 offset:36864
    v_mfma_f32_32x32x16_bf16 v[128:143], v[24:27], v[20:23], v[128:143]
    ds_read_b64_tr_b16 v[50:51], v8 offset:37888
    ds_read_b128 v[44:47], v5 offset:20480
    v_mfma_f32_32x32x16_bf16 v[80:95], v[28:31], v[16:19], v[80:95]
    ds_read_b64_tr_b16 v[52:53], v9 offset:36864
    ds_read_b64_tr_b16 v[54:55], v9 offset:37888
    v_mfma_f32_32x32x16_bf16 v[144:159], v[28:31], v[20:23], v[144:159]
    ds_read_b64_tr_b16 v[56:57], v10 offset:36864
    ds_read_b64_tr_b16 v[58:59], v10 offset:37888
    v_mfma_f32_32x32x16_bf16 v[96:111], v[32:35], v[16:19], v[96:111]
    ds_read_b64_tr_b16 v[60:61], v11 offset:36864
    ds_read_b64_tr_b16 v[62:63], v11 offset:37888
    v_mfma_f32_32x32x16_bf16 v[160:175], v[32:35], v[20:23], v[160:175]
    v_mfma_f32_32x32x16_bf16 v[112:127], v[36:39], v[16:19], v[112:127]
    v_mfma_f32_32x32x16_bf16 v[176:191], v[36:39], v[20:23], v[176:191]
    s_waitcnt vmcnt(8) lgkmcnt(0)
    s_barrier
    v_mfma_f32_32x32x16_bf16 v[64:79], v[48:51], v[40:43], v[64:79]
    ds_read_b128 v[16:19], v6 offset:16384
    ds_read_b64_tr_b16 v[24:25], v8 offset:0
    s_add_u32 m0, s36, 32768
    s_add_u32 s38, s63, 114688
    buffer_load_dwordx4 v2, s[12:15], s38 offen lds
    v_mfma_f32_32x32x16_bf16 v[128:143], v[48:51], v[44:47], v[128:143]
    ds_read_b64_tr_b16 v[26:27], v8 offset:1024
    ds_read_b128 v[20:23], v6 offset:20480
    s_add_u32 m0, s36, 40960
    s_add_u32 s38, s63, 114688
    buffer_load_dwordx4 v3, s[16:19], s38 offen lds
    v_mfma_f32_32x32x16_bf16 v[80:95], v[52:55], v[40:43], v[80:95]
    ds_read_b64_tr_b16 v[28:29], v9 offset:0
    ds_read_b64_tr_b16 v[30:31], v9 offset:1024
    s_add_u32 m0, s36, 36864
    s_add_u32 s38, s63, 172032
    buffer_load_dwordx4 v2, s[12:15], s38 offen lds
    v_mfma_f32_32x32x16_bf16 v[144:159], v[52:55], v[44:47], v[144:159]
    ds_read_b64_tr_b16 v[32:33], v10 offset:0
    ds_read_b64_tr_b16 v[34:35], v10 offset:1024
    s_add_u32 m0, s36, 45056
    s_add_u32 s38, s63, 172032
    buffer_load_dwordx4 v3, s[16:19], s38 offen lds
    v_mfma_f32_32x32x16_bf16 v[96:111], v[56:59], v[40:43], v[96:111]
    ds_read_b64_tr_b16 v[36:37], v11 offset:0
    ds_read_b64_tr_b16 v[38:39], v11 offset:1024
    v_mfma_f32_32x32x16_bf16 v[160:175], v[56:59], v[44:47], v[160:175]
    v_mfma_f32_32x32x16_bf16 v[112:127], v[60:63], v[40:43], v[112:127]
    v_mfma_f32_32x32x16_bf16 v[176:191], v[60:63], v[44:47], v[176:191]
    s_waitcnt lgkmcnt(0)
    v_mfma_f32_32x32x16_bf16 v[64:79], v[24:27], v[16:19], v[64:79]
    ds_read_b128 v[40:43], v7 offset:16384
    ds_read_b64_tr_b16 v[48:49], v8 offset:4096
    v_mfma_f32_32x32x16_bf16 v[128:143], v[24:27], v[20:23], v[128:143]
    ds_read_b64_tr_b16 v[50:51], v8 offset:5120
    ds_read_b128 v[44:47], v7 offset:20480
    v_mfma_f32_32x32x16_bf16 v[80:95], v[28:31], v[16:19], v[80:95]
    ds_read_b64_tr_b16 v[52:53], v9 offset:4096
    ds_read_b64_tr_b16 v[54:55], v9 offset:5120
    v_mfma_f32_32x32x16_bf16 v[144:159], v[28:31], v[20:23], v[144:159]
    ds_read_b64_tr_b16 v[56:57], v10 offset:4096
    ds_read_b64_tr_b16 v[58:59], v10 offset:5120
    v_mfma_f32_32x32x16_bf16 v[96:111], v[32:35], v[16:19], v[96:111]
    ds_read_b64_tr_b16 v[60:61], v11 offset:4096
    ds_read_b64_tr_b16 v[62:63], v11 offset:5120
    v_mfma_f32_32x32x16_bf16 v[160:175], v[32:35], v[20:23], v[160:175]
    v_mfma_f32_32x32x16_bf16 v[112:127], v[36:39], v[16:19], v[112:127]
    v_mfma_f32_32x32x16_bf16 v[176:191], v[36:39], v[20:23], v[176:191]
    s_waitcnt vmcnt(4) lgkmcnt(0)
    s_barrier
    v_mfma_f32_32x32x16_bf16 v[64:79], v[48:51], v[40:43], v[64:79]
    ds_read_b128 v[16:19], v4 offset:0
    ds_read_b64_tr_b16 v[24:25], v8 offset:16384
    s_mul_i32 s63, s62, 229376
    s_add_u32 s63, s63, s35
    s_add_u32 s62, s62, 1
    s_cmp_eq_u32 s62, 7
    s_cselect_b32 s62, 0, s62
    s_add_u32 m0, s36, 0
    s_add_u32 s38, s63, 0
    buffer_load_dwordx4 v2, s[12:15], s38 offen lds
    v_mfma_f32_32x32x16_bf16 v[128:143], v[48:51], v[44:47], v[128:143]
    ds_read_b64_tr_b16 v[26:27], v8 offset:17408
    ds_read_b128 v[20:23], v4 offset:4096
    s_add_u32 m0, s36, 8192
    s_add_u32 s38, s63, 0
    buffer_load_dwordx4 v3, s[16:19], s38 offen lds
    v_mfma_f32_32x32x16_bf16 v[80:95], v[52:55], v[40:43], v[80:95]
    ds_read_b64_tr_b16 v[28:29], v9 offset:16384
    ds_read_b64_tr_b16 v[30:31], v9 offset:17408
    s_add_u32 m0, s36, 4096
    s_add_u32 s38, s63, 57344
    buffer_load_dwordx4 v2, s[12:15], s38 offen lds
    v_mfma_f32_32x32x16_bf16 v[144:159], v[52:55], v[44:47], v[144:159]
    ds_read_b64_tr_b16 v[32:33], v10 offset:16384
    ds_read_b64_tr_b16 v[34:35], v10 offset:17408
    s_add_u32 m0, s36, 12288
    s_add_u32 s38, s63, 57344
    buffer_load_dwordx4 v3, s[16:19], s38 offen lds
    v_mfma_f32_32x32x16_bf16 v[96:111], v[56:59], v[40:43], v[96:111]
    ds_read_b64_tr_b16 v[36:37], v11 offset:16384
    ds_read_b64_tr_b16 v[38:39], v11 offset:17408
    s_lshl_b32 s61, s60, 7
    s_add_u32 s61, s61, s34
    s_add_u32 s60, s60, 1
    s_cmp_eq_u32 s60, 7
    s_cselect_b32 s60, 0, s60
    s_add_u32 m0, s36, 65536
    s_add_u32 s38, s61, 0
    buffer_load_dwordx4 v1, s[8:11], s38 offen lds
    v_mfma_f32_32x32x16_bf16 v[160:175], v[56:59], v[44:47], v[160:175]
    s_add_u32 m0, s36, 69632
    s_add_u32 s38, s61, 28672
    buffer_load_dwordx4 v1, s[8:11], s38 offen lds
    v_mfma_f32_32x32x16_bf16 v[112:127], v[60:63], v[40:43], v[112:127]
    s_add_u32 m0, s36, 73728
    s_add_u32 s38, s61, 57344
    buffer_load_dwordx4 v1, s[8:11], s38 offen lds
    v_mfma_f32_32x32x16_bf16 v[176:191], v[60:63], v[44:47], v[176:191]
    s_add_u32 m0, s36, 77824
    s_add_u32 s38, s61, 86016
    buffer_load_dwordx4 v1, s[8:11], s38 offen lds
    s_waitcnt lgkmcnt(0)
    v_mfma_f32_32x32x16_bf16 v[64:79], v[24:27], v[16:19], v[64:79]
    ds_read_b128 v[40:43], v5 offset:0
    ds_read_b64_tr_b16 v[48:49], v8 offset:20480
    v_mfma_f32_32x32x16_bf16 v[128:143], v[24:27], v[20:23], v[128:143]
    ds_read_b64_tr_b16 v[50:51], v8 offset:21504
    ds_read_b128 v[44:47], v5 offset:4096
    v_mfma_f32_32x32x16_bf16 v[80:95], v[28:31], v[16:19], v[80:95]
    ds_read_b64_tr_b16 v[52:53], v9 offset:20480
    ds_read_b64_tr_b16 v[54:55], v9 offset:21504
    v_mfma_f32_32x32x16_bf16 v[144:159], v[28:31], v[20:23], v[144:159]
    ds_read_b64_tr_b16 v[56:57], v10 offset:20480
    ds_read_b64_tr_b16 v[58:59], v10 offset:21504
    v_mfma_f32_32x32x16_bf16 v[96:111], v[32:35], v[16:19], v[96:111]
    ds_read_b64_tr_b16 v[60:61], v11 offset:20480
    ds_read_b64_tr_b16 v[62:63], v11 offset:21504
    v_mfma_f32_32x32x16_bf16 v[160:175], v[32:35], v[20:23], v[160:175]
    v_mfma_f32_32x32x16_bf16 v[112:127], v[36:39], v[16:19], v[112:127]
    v_mfma_f32_32x32x16_bf16 v[176:191], v[36:39], v[20:23], v[176:191]
    s_waitcnt vmcnt(8) lgkmcnt(0)
    s_barrier
    v_mfma_f32_32x32x16_bf16 v[64:79], v[48:51], v[40:43], v[64:79]
    ds_read_b128 v[16:19], v6 offset:0
    ds_read_b64_tr_b16 v[24:25], v8 offset:32768
    s_add_u32 m0, s36, 16384
    s_add_u32 s38, s63, 114688
    buffer_load_dwordx4 v2, s[12:15], s38 offen lds
    v_mfma_f32_32x32x16_bf16 v[128:143], v[48:51], v[44:47], v[128:143]
    ds_read_b64_tr_b16 v[26:27], v8 offset:33792
    ds_read_b128 v[20:23], v6 offset:4096
    s_add_u32 m0, s36, 24576
    s_add_u32 s38, s63, 114688
    buffer_load_dwordx4 v3, s[16:19], s38 offen lds
    v_mfma_f32_32x32x16_bf16 v[80:95], v[52:55], v[40:43], v[80:95]
    ds_read_b64_tr_b16 v[28:29], v9 offset:32768
    ds_read_b64_tr_b16 v[30:31], v9 offset:33792
    s_add_u32 m0, s36, 20480
    s_add_u32 s38, s63, 172032
    buffer_load_dwordx4 v2, s[12:15], s38 offen lds
    v_mfma_f32_32x32x16_bf16 v[144:159], v[52:55], v[44:47], v[144:159]
    ds_read_b64_tr_b16 v[32:33], v10 offset:32768
    ds_read_b64_tr_b16 v[34:35], v10 offset:33792
    s_add_u32 m0, s36, 28672
    s_add_u32 s38, s63, 172032
    buffer_load_dwordx4 v3, s[16:19], s38 offen lds
    v_mfma_f32_32x32x16_bf16 v[96:111], v[56:59], v[40:43], v[96:111]
    ds_read_b64_tr_b16 v[36:37], v11 offset:32768
    ds_read_b64_tr_b16 v[38:39], v11 offset:33792
    v_mfma_f32_32x32x16_bf16 v[160:175], v[56:59], v[44:47], v[160:175]
    v_mfma_f32_32x32x16_bf16 v[112:127], v[60:63], v[40:43], v[112:127]
    v_mfma_f32_32x32x16_bf16 v[176:191], v[60:63], v[44:47], v[176:191]
    s_waitcnt lgkmcnt(0)
    v_mfma_f32_32x32x16_bf16 v[64:79], v[24:27], v[16:19], v[64:79]
    ds_read_b128 v[40:43], v7 offset:0
    ds_read_b64_tr_b16 v[48:49], v8 offset:36864
    v_mfma_f32_32x32x16_bf16 v[128:143], v[24:27], v[20:23], v[128:143]
    ds_read_b64_tr_b16 v[50:51], v8 offset:37888
    ds_read_b128 v[44:47], v7 offset:4096
    v_mfma_f32_32x32x16_bf16 v[80:95], v[28:31], v[16:19], v[80:95]
    ds_read_b64_tr_b16 v[52:53], v9 offset:36864
    ds_read_b64_tr_b16 v[54:55], v9 offset:37888
    v_mfma_f32_32x32x16_bf16 v[144:159], v[28:31], v[20:23], v[144:159]
    ds_read_b64_tr_b16 v[56:57], v10 offset:36864
    ds_read_b64_tr_b16 v[58:59], v10 offset:37888
    v_mfma_f32_32x32x16_bf16 v[96:111], v[32:35], v[16:19], v[96:111]
    ds_read_b64_tr_b16 v[60:61], v11 offset:36864
    ds_read_b64_tr_b16 v[62:63], v11 offset:37888
    v_mfma_f32_32x32x16_bf16 v[160:175], v[32:35], v[20:23], v[160:175]
    v_mfma_f32_32x32x16_bf16 v[112:127], v[36:39], v[16:19], v[112:127]
    v_mfma_f32_32x32x16_bf16 v[176:191], v[36:39], v[20:23], v[176:191]
    s_waitcnt vmcnt(4) lgkmcnt(0)
    s_barrier
    v_mfma_f32_32x32x16_bf16 v[64:79], v[48:51], v[40:43], v[64:79]
    ds_read_b128 v[16:19], v4 offset:16384
    ds_read_b64_tr_b16 v[24:25], v8 offset:0
    s_mul_i32 s63, s62, 229376
    s_add_u32 s63, s63, s35
    s_add_u32 s62, s62, 1
    s_cmp_eq_u32 s62, 7
    s_cselect_b32 s62, 0, s62
    s_add_u32 m0, s36, 32768
    s_add_u32 s38, s63, 0
    buffer_load_dwordx4 v2, s[12:15], s38 offen lds
    v_mfma_f32_32x32x16_bf16 v[128:143], v[48:51], v[44:47], v[128:143]
    ds_read_b64_tr_b16 v[26:27], v8 offset:1024
    ds_read_b128 v[20:23], v4 offset:20480
    s_add_u32 m0, s36, 40960
    s_add_u32 s38, s63, 0
    buffer_load_dwordx4 v3, s[16:19], s38 offen lds
    v_mfma_f32_32x32x16_bf16 v[80:95], v[52:55], v[40:43], v[80:95]
    ds_read_b64_tr_b16 v[28:29], v9 offset:0
    ds_read_b64_tr_b16 v[30:31], v9 offset:1024
    s_add_u32 m0, s36, 36864
    s_add_u32 s38, s63, 57344
    buffer_load_dwordx4 v2, s[12:15], s38 offen lds
    v_mfma_f32_32x32x16_bf16 v[144:159], v[52:55], v[44:47], v[144:159]
    ds_read_b64_tr_b16 v[32:33], v10 offset:0
    ds_read_b64_tr_b16 v[34:35], v10 offset:1024
    s_add_u32 m0, s36, 45056
    s_add_u32 s38, s63, 57344
    buffer_load_dwordx4 v3, s[16:19], s38 offen lds
    v_mfma_f32_32x32x16_bf16 v[96:111], v[56:59], v[40:43], v[96:111]
    ds_read_b64_tr_b16 v[36:37], v11 offset:0
    ds_read_b64_tr_b16 v[38:39], v11 offset:1024
    s_lshl_b32 s61, s60, 7
    s_add_u32 s61, s61, s34
    s_add_u32 s60, s60, 1
    s_cmp_eq_u32 s60, 7
    s_cselect_b32 s60, 0, s60
    s_add_u32 m0, s36, 49152
    s_add_u32 s38, s61, 0
    buffer_load_dwordx4 v1, s[8:11], s38 offen lds
    v_mfma_f32_32x32x16_bf16 v[160:175], v[56:59], v[44:47], v[160:175]
    s_add_u32 m0, s36, 53248
    s_add_u32 s38, s61, 28672
    buffer_load_dwordx4 v1, s[8:11], s38 offen lds
    v_mfma_f32_32x32x16_bf16 v[112:127], v[60:63], v[40:43], v[112:127]
    s_add_u32 m0, s36, 57344
    s_add_u32 s38, s61, 57344
    buffer_load_dwordx4 v1, s[8:11], s38 offen lds
    v_mfma_f32_32x32x16_bf16 v[176:191], v[60:63], v[44:47], v[176:191]
    s_add_u32 m0, s36, 61440
    s_add_u32 s38, s61, 86016
    buffer_load_dwordx4 v1, s[8:11], s38 offen lds
    s_waitcnt lgkmcnt(0)
    v_mfma_f32_32x32x16_bf16 v[64:79], v[24:27], v[16:19], v[64:79]
    ds_read_b128 v[40:43], v5 offset:16384
    ds_read_b64_tr_b16 v[48:49], v8 offset:4096
    v_mfma_f32_32x32x16_bf16 v[128:143], v[24:27], v[20:23], v[128:143]
    ds_read_b64_tr_b16 v[50:51], v8 offset:5120
    ds_read_b128 v[44:47], v5 offset:20480
    v_mfma_f32_32x32x16_bf16 v[80:95], v[28:31], v[16:19], v[80:95]
    ds_read_b64_tr_b16 v[52:53], v9 offset:4096
    ds_read_b64_tr_b16 v[54:55], v9 offset:5120
    v_mfma_f32_32x32x16_bf16 v[144:159], v[28:31], v[20:23], v[144:159]
    ds_read_b64_tr_b16 v[56:57], v10 offset:4096
    ds_read_b64_tr_b16 v[58:59], v10 offset:5120
    v_mfma_f32_32x32x16_bf16 v[96:111], v[32:35], v[16:19], v[96:111]
    ds_read_b64_tr_b16 v[60:61], v11 offset:4096
    ds_read_b64_tr_b16 v[62:63], v11 offset:5120
    v_mfma_f32_32x32x16_bf16 v[160:175], v[32:35], v[20:23], v[160:175]
    v_mfma_f32_32x32x16_bf16 v[112:127], v[36:39], v[16:19], v[112:127]
    v_mfma_f32_32x32x16_bf16 v[176:191], v[36:39], v[20:23], v[176:191]
    s_waitcnt vmcnt(8) lgkmcnt(0)
    s_barrier
    v_mfma_f32_32x32x16_bf16 v[64:79], v[48:51], v[40:43], v[64:79]
    ds_read_b128 v[16:19], v6 offset:16384
    ds_read_b64_tr_b16 v[24:25], v8 offset:16384
    s_add_u32 m0, s36, 0
    s_add_u32 s38, s63, 114688
    buffer_load_dwordx4 v2, s[12:15], s38 offen lds
    v_mfma_f32_32x32x16_bf16 v[128:143], v[48:51], v[44:47], v[128:143]
    ds_read_b64_tr_b16 v[26:27], v8 offset:17408
    ds_read_b128 v[20:23], v6 offset:20480
    s_add_u32 m0, s36, 8192
    s_add_u32 s38, s63, 114688
    buffer_load_dwordx4 v3, s[16:19], s38 offen lds
    v_mfma_f32_32x32x16_bf16 v[80:95], v[52:55], v[40:43], v[80:95]
    ds_read_b64_tr_b16 v[28:29], v9 offset:16384
    ds_read_b64_tr_b16 v[30:31], v9 offset:17408
    s_add_u32 m0, s36, 4096
    s_add_u32 s38, s63, 172032
    buffer_load_dwordx4 v2, s[12:15], s38 offen lds
    v_mfma_f32_32x32x16_bf16 v[144:159], v[52:55], v[44:47], v[144:159]
    ds_read_b64_tr_b16 v[32:33], v10 offset:16384
    ds_read_b64_tr_b16 v[34:35], v10 offset:17408
    s_add_u32 m0, s36, 12288
    s_add_u32 s38, s63, 172032
    buffer_load_dwordx4 v3, s[16:19], s38 offen lds
    v_mfma_f32_32x32x16_bf16 v[96:111], v[56:59], v[40:43], v[96:111]
    ds_read_b64_tr_b16 v[36:37], v11 offset:16384
    ds_read_b64_tr_b16 v[38:39], v11 offset:17408
    v_mfma_f32_32x32x16_bf16 v[160:175], v[56:59], v[44:47], v[160:175]
    v_mfma_f32_32x32x16_bf16 v[112:127], v[60:63], v[40:43], v[112:127]
    v_mfma_f32_32x32x16_bf16 v[176:191], v[60:63], v[44:47], v[176:191]
    s_waitcnt lgkmcnt(0)
    v_mfma_f32_32x32x16_bf16 v[64:79], v[24:27], v[16:19], v[64:79]
    ds_read_b128 v[40:43], v7 offset:16384
    ds_read_b64_tr_b16 v[48:49], v8 offset:20480
    v_mfma_f32_32x32x16_bf16 v[128:143], v[24:27], v[20:23], v[128:143]
    ds_read_b64_tr_b16 v[50:51], v8 offset:21504
    ds_read_b128 v[44:47], v7 offset:20480
    v_mfma_f32_32x32x16_bf16 v[80:95], v[28:31], v[16:19], v[80:95]
    ds_read_b64_tr_b16 v[52:53], v9 offset:20480
    ds_read_b64_tr_b16 v[54:55], v9 offset:21504
    v_mfma_f32_32x32x16_bf16 v[144:159], v[28:31], v[20:23], v[144:159]
    ds_read_b64_tr_b16 v[56:57], v10 offset:20480
    ds_read_b64_tr_b16 v[58:59], v10 offset:21504
    v_mfma_f32_32x32x16_bf16 v[96:111], v[32:35], v[16:19], v[96:111]
    ds_read_b64_tr_b16 v[60:61], v11 offset:20480
    ds_read_b64_tr_b16 v[62:63], v11 offset:21504
    v_mfma_f32_32x32x16_bf16 v[160:175], v[32:35], v[20:23], v[160:175]
    v_mfma_f32_32x32x16_bf16 v[112:127], v[36:39], v[16:19], v[112:127]
    v_mfma_f32_32x32x16_bf16 v[176:191], v[36:39], v[20:23], v[176:191]
    s_waitcnt vmcnt(4) lgkmcnt(0)
    s_barrier
    v_mfma_f32_32x32x16_bf16 v[64:79], v[48:51], v[40:43], v[64:79]
    ds_read_b128 v[16:19], v4 offset:0
    ds_read_b64_tr_b16 v[24:25], v8 offset:32768
    s_mul_i32 s63, s62, 229376
    s_add_u32 s63, s63, s35
    s_add_u32 s62, s62, 1
    s_cmp_eq_u32 s62, 7
    s_cselect_b32 s62, 0, s62
    s_add_u32 m0, s36, 16384
    s_add_u32 s38, s63, 0
    buffer_load_dwordx4 v2, s[12:15], s38 offen lds
    v_mfma_f32_32x32x16_bf16 v[128:143], v[48:51], v[44:47], v[128:143]
    ds_read_b64_tr_b16 v[26:27], v8 offset:33792
    ds_read_b128 v[20:23], v4 offset:4096
    s_add_u32 m0, s36, 24576
    s_add_u32 s38, s63, 0
    buffer_load_dwordx4 v3, s[16:19], s38 offen lds
    v_mfma_f32_32x32x16_bf16 v[80:95], v[52:55], v[40:43], v[80:95]
    ds_read_b64_tr_b16 v[28:29], v9 offset:32768
    ds_read_b64_tr_b16 v[30:31], v9 offset:33792
    s_add_u32 m0, s36, 20480
    s_add_u32 s38, s63, 57344
    buffer_load_dwordx4 v2, s[12:15], s38 offen lds
    v_mfma_f32_32x32x16_bf16 v[144:159], v[52:55], v[44:47], v[144:159]
    ds_read_b64_tr_b16 v[32:33], v10 offset:32768
    ds_read_b64_tr_b16 v[34:35], v10 offset:33792
    s_add_u32 m0, s36, 28672
    s_add_u32 s38, s63, 57344
    buffer_load_dwordx4 v3, s[16:19], s38 offen lds
    v_mfma_f32_32x32x16_bf16 v[96:111], v[56:59], v[40:43], v[96:111]
    ds_read_b64_tr_b16 v[36:37], v11 offset:32768
    ds_read_b64_tr_b16 v[38:39], v11 offset:33792
    s_lshl_b32 s61, s60, 7
    s_add_u32 s61, s61, s34
    s_add_u32 s60, s60, 1
    s_cmp_eq_u32 s60, 7
    s_cselect_b32 s60, 0, s60
    s_add_u32 m0, s36, 65536
    s_add_u32 s38, s61, 0
    buffer_load_dwordx4 v1, s[8:11], s38 offen lds
    v_mfma_f32_32x32x16_bf16 v[160:175], v[56:59], v[44:47], v[160:175]
    s_add_u32 m0, s36, 69632
    s_add_u32 s38, s61, 28672
    buffer_load_dwordx4 v1, s[8:11], s38 offen lds
    v_mfma_f32_32x32x16_bf16 v[112:127], v[60:63], v[40:43], v[112:127]
    s_add_u32 m0, s36, 73728
    s_add_u32 s38, s61, 57344
    buffer_load_dwordx4 v1, s[8:11], s38 offen lds
    v_mfma_f32_32x32x16_bf16 v[176:191], v[60:63], v[44:47], v[176:191]
    s_add_u32 m0, s36, 77824
    s_add_u32 s38, s61, 86016
    buffer_load_dwordx4 v1, s[8:11], s38 offen lds
    s_waitcnt lgkmcnt(0)
    v_mfma_f32_32x32x16_bf16 v[64:79], v[24:27], v[16:19], v[64:79]
    ds_read_b128 v[40:43], v5 offset:0
    ds_read_b64_tr_b16 v[48:49], v8 offset:36864
    v_mfma_f32_32x32x16_bf16 v[128:143], v[24:27], v[20:23], v[128:143]
    ds_read_b64_tr_b16 v[50:51], v8 offset:37888
    ds_read_b128 v[44:47], v5 offset:4096
    v_mfma_f32_32x32x16_bf16 v[80:95], v[28:31], v[16:19], v[80:95]
    ds_read_b64_tr_b16 v[52:53], v9 offset:36864
    ds_read_b64_tr_b16 v[54:55], v9 offset:37888
    v_mfma_f32_32x32x16_bf16 v[144:159], v[28:31], v[20:23], v[144:159]
    ds_read_b64_tr_b16 v[56:57], v10 offset:36864
    ds_read_b64_tr_b16 v[58:59], v10 offset:37888
    v_mfma_f32_32x32x16_bf16 v[96:111], v[32:35], v[16:19], v[96:111]
    ds_read_b64_tr_b16 v[60:61], v11 offset:36864
    ds_read_b64_tr_b16 v[62:63], v11 offset:37888
    v_mfma_f32_32x32x16_bf16 v[160:175], v[32:35], v[20:23], v[160:175]
    v_mfma_f32_32x32x16_bf16 v[112:127], v[36:39], v[16:19], v[112:127]
    v_mfma_f32_32x32x16_bf16 v[176:191], v[36:39], v[20:23], v[176:191]
    s_waitcnt vmcnt(8) lgkmcnt(0)
    s_barrier
    v_mfma_f32_32x32x16_bf16 v[64:79], v[48:51], v[40:43], v[64:79]
    ds_read_b128 v[16:19], v6 offset:0
    ds_read_b64_tr_b16 v[24:25], v8 offset:0
    s_add_u32 m0, s36, 32768
    s_add_u32 s38, s63, 114688
    buffer_load_dwordx4 v2, s[12:15], s38 offen lds
    v_mfma_f32_32x32x16_bf16 v[128:143], v[48:51], v[44:47], v[128:143]
    ds_read_b64_tr_b16 v[26:27], v8 offset:1024
    ds_read_b128 v[20:23], v6 offset:4096
    s_add_u32 m0, s36, 40960
    s_add_u32 s38, s63, 114688
    buffer_load_dwordx4 v3, s[16:19], s38 offen lds
    v_mfma_f32_32x32x16_bf16 v[80:95], v[52:55], v[40:43], v[80:95]
    ds_read_b64_tr_b16 v[28:29], v9 offset:0
    ds_read_b64_tr_b16 v[30:31], v9 offset:1024
    s_add_u32 m0, s36, 36864
    s_add_u32 s38, s63, 172032
    buffer_load_dwordx4 v2, s[12:15], s38 offen lds
    v_mfma_f32_32x32x16_bf16 v[144:159], v[52:55], v[44:47], v[144:159]
    ds_read_b64_tr_b16 v[32:33], v10 offset:0
    ds_read_b64_tr_b16 v[34:35], v10 offset:1024
    s_add_u32 m0, s36, 45056
    s_add_u32 s38, s63, 172032
    buffer_load_dwordx4 v3, s[16:19], s38 offen lds
    v_mfma_f32_32x32x16_bf16 v[96:111], v[56:59], v[40:43], v[96:111]
    ds_read_b64_tr_b16 v[36:37], v11 offset:0
    ds_read_b64_tr_b16 v[38:39], v11 offset:1024
    v_mfma_f32_32x32x16_bf16 v[160:175], v[56:59], v[44:47], v[160:175]
    v_mfma_f32_32x32x16_bf16 v[112:127], v[60:63], v[40:43], v[112:127]
    v_mfma_f32_32x32x16_bf16 v[176:191], v[60:63], v[44:47], v[176:191]
    s_waitcnt lgkmcnt(0)
    v_mfma_f32_32x32x16_bf16 v[64:79], v[24:27], v[16:19], v[64:79]
    ds_read_b128 v[40:43], v7 offset:0
    ds_read_b64_tr_b16 v[48:49], v8 offset:4096
    v_mfma_f32_32x32x16_bf16 v[128:143], v[24:27], v[20:23], v[128:143]
    ds_read_b64_tr_b16 v[50:51], v8 offset:5120
    ds_read_b128 v[44:47], v7 offset:4096
    v_mfma_f32_32x32x16_bf16 v[80:95], v[28:31], v[16:19], v[80:95]
    ds_read_b64_tr_b16 v[52:53], v9 offset:4096
    ds_read_b64_tr_b16 v[54:55], v9 offset:5120
    v_mfma_f32_32x32x16_bf16 v[144:159], v[28:31], v[20:23], v[144:159]
    ds_read_b64_tr_b16 v[56:57], v10 offset:4096
    ds_read_b64_tr_b16 v[58:59], v10 offset:5120
    v_mfma_f32_32x32x16_bf16 v[96:111], v[32:35], v[16:19], v[96:111]
    ds_read_b64_tr_b16 v[60:61], v11 offset:4096
    ds_read_b64_tr_b16 v[62:63], v11 offset:5120
    v_mfma_f32_32x32x16_bf16 v[160:175], v[32:35], v[20:23], v[160:175]
    v_mfma_f32_32x32x16_bf16 v[112:127], v[36:39], v[16:19], v[112:127]
    v_mfma_f32_32x32x16_bf16 v[176:191], v[36:39], v[20:23], v[176:191]
    s_waitcnt vmcnt(4) lgkmcnt(0)
    s_barrier
    v_mfma_f32_32x32x16_bf16 v[64:79], v[48:51], v[40:43], v[64:79]
    ds_read_b128 v[16:19], v4 offset:16384
    ds_read_b64_tr_b16 v[24:25], v8 offset:16384
    s_mul_i32 s63, s62, 229376
    s_add_u32 s63, s63, s35
    s_add_u32 s62, s62, 1
    s_cmp_eq_u32 s62, 7
    s_cselect_b32 s62, 0, s62
    s_add_u32 m0, s36, 0
    s_add_u32 s38, s63, 0
    buffer_load_dwordx4 v2, s[12:15], s38 offen lds
    v_mfma_f32_32x32x16_bf16 v[128:143], v[48:51], v[44:47], v[128:143]
    ds_read_b64_tr_b16 v[26:27], v8 offset:17408
    ds_read_b128 v[20:23], v4 offset:20480
    s_add_u32 m0, s36, 8192
    s_add_u32 s38, s63, 0
    buffer_load_dwordx4 v3, s[16:19], s38 offen lds
    v_mfma_f32_32x32x16_bf16 v[80:95], v[52:55], v[40:43], v[80:95]
    ds_read_b64_tr_b16 v[28:29], v9 offset:16384
    ds_read_b64_tr_b16 v[30:31], v9 offset:17408
    s_add_u32 m0, s36, 4096
    s_add_u32 s38, s63, 57344
    buffer_load_dwordx4 v2, s[12:15], s38 offen lds
    v_mfma_f32_32x32x16_bf16 v[144:159], v[52:55], v[44:47], v[144:159]
    ds_read_b64_tr_b16 v[32:33], v10 offset:16384
    ds_read_b64_tr_b16 v[34:35], v10 offset:17408
    s_add_u32 m0, s36, 12288
    s_add_u32 s38, s63, 57344
    buffer_load_dwordx4 v3, s[16:19], s38 offen lds
    v_mfma_f32_32x32x16_bf16 v[96:111], v[56:59], v[40:43], v[96:111]
    ds_read_b64_tr_b16 v[36:37], v11 offset:16384
    ds_read_b64_tr_b16 v[38:39], v11 offset:17408
    s_lshl_b32 s61, s60, 7
    s_add_u32 s61, s61, s34
    s_add_u32 s60, s60, 1
    s_cmp_eq_u32 s60, 7
    s_cselect_b32 s60, 0, s60
    s_add_u32 m0, s36, 49152
    s_add_u32 s38, s61, 0
    buffer_load_dwordx4 v1, s[8:11], s38 offen lds
    v_mfma_f32_32x32x16_bf16 v[160:175], v[56:59], v[44:47], v[160:175]
    s_add_u32 m0, s36, 53248
    s_add_u32 s38, s61, 28672
    buffer_load_dwordx4 v1, s[8:11], s38 offen lds
    v_mfma_f32_32x32x16_bf16 v[112:127], v[60:63], v[40:43], v[112:127]
    s_add_u32 m0, s36, 57344
    s_add_u32 s38, s61, 57344
    buffer_load_dwordx4 v1, s[8:11], s38 offen lds
    v_mfma_f32_32x32x16_bf16 v[176:191], v[60:63], v[44:47], v[176:191]
    s_add_u32 m0, s36, 61440
    s_add_u32 s38, s61, 86016
    buffer_load_dwordx4 v1, s[8:11], s38 offen lds
    s_waitcnt lgkmcnt(0)
    v_mfma_f32_32x32x16_bf16 v[64:79], v[24:27], v[16:19], v[64:79]
    ds_read_b128 v[40:43], v5 offset:16384
    ds_read_b64_tr_b16 v[48:49], v8 offset:20480
    v_mfma_f32_32x32x16_bf16 v[128:143], v[24:27], v[20:23], v[128:143]
    ds_read_b64_tr_b16 v[50:51], v8 offset:21504
    ds_read_b128 v[44:47], v5 offset:20480
    v_mfma_f32_32x32x16_bf16 v[80:95], v[28:31], v[16:19], v[80:95]
    ds_read_b64_tr_b16 v[52:53], v9 offset:20480
    ds_read_b64_tr_b16 v[54:55], v9 offset:21504
    v_mfma_f32_32x32x16_bf16 v[144:159], v[28:31], v[20:23], v[144:159]
    ds_read_b64_tr_b16 v[56:57], v10 offset:20480
    ds_read_b64_tr_b16 v[58:59], v10 offset:21504
    v_mfma_f32_32x32x16_bf16 v[96:111], v[32:35], v[16:19], v[96:111]
    ds_read_b64_tr_b16 v[60:61], v11 offset:20480
    ds_read_b64_tr_b16 v[62:63], v11 offset:21504
    v_mfma_f32_32x32x16_bf16 v[160:175], v[32:35], v[20:23], v[160:175]
    v_mfma_f32_32x32x16_bf16 v[112:127], v[36:39], v[16:19], v[112:127]
    v_mfma_f32_32x32x16_bf16 v[176:191], v[36:39], v[20:23], v[176:191]
    s_waitcnt vmcnt(8) lgkmcnt(0)
    s_barrier
    v_mfma_f32_32x32x16_bf16 v[64:79], v[48:51], v[40:43], v[64:79]
    ds_read_b128 v[16:19], v6 offset:16384
    ds_read_b64_tr_b16 v[24:25], v8 offset:32768
    s_add_u32 m0, s36, 16384
    s_add_u32 s38, s63, 114688
    buffer_load_dwordx4 v2, s[12:15], s38 offen lds
    v_mfma_f32_32x32x16_bf16 v[128:143], v[48:51], v[44:47], v[128:143]
    ds_read_b64_tr_b16 v[26:27], v8 offset:33792
    ds_read_b128 v[20:23], v6 offset:20480
    s_add_u32 m0, s36, 24576
    s_add_u32 s38, s63, 114688
    buffer_load_dwordx4 v3, s[16:19], s38 offen lds
    v_mfma_f32_32x32x16_bf16 v[80:95], v[52:55], v[40:43], v[80:95]
    ds_read_b64_tr_b16 v[28:29], v9 offset:32768
    ds_read_b64_tr_b16 v[30:31], v9 offset:33792
    s_add_u32 m0, s36, 20480
    s_add_u32 s38, s63, 172032
    buffer_load_dwordx4 v2, s[12:15], s38 offen lds
    v_mfma_f32_32x32x16_bf16 v[144:159], v[52:55], v[44:47], v[144:159]
    ds_read_b64_tr_b16 v[32:33], v10 offset:32768
    ds_read_b64_tr_b16 v[34:35], v10 offset:33792
    s_add_u32 m0, s36, 28672
    s_add_u32 s38, s63, 172032
    buffer_load_dwordx4 v3, s[16:19], s38 offen lds
    v_mfma_f32_32x32x16_bf16 v[96:111], v[56:59], v[40:43], v[96:111]
    ds_read_b64_tr_b16 v[36:37], v11 offset:32768
    ds_read_b64_tr_b16 v[38:39], v11 offset:33792
    v_mfma_f32_32x32x16_bf16 v[160:175], v[56:59], v[44:47], v[160:175]
    v_mfma_f32_32x32x16_bf16 v[112:127], v[60:63], v[40:43], v[112:127]
    v_mfma_f32_32x32x16_bf16 v[176:191], v[60:63], v[44:47], v[176:191]
    s_waitcnt lgkmcnt(0)
    v_mfma_f32_32x32x16_bf16 v[64:79], v[24:27], v[16:19], v[64:79]
    ds_read_b128 v[40:43], v7 offset:16384
    ds_read_b64_tr_b16 v[48:49], v8 offset:36864
    v_mfma_f32_32x32x16_bf16 v[128:143], v[24:27], v[20:23], v[128:143]
    ds_read_b64_tr_b16 v[50:51], v8 offset:37888
    ds_read_b128 v[44:47], v7 offset:20480
    v_mfma_f32_32x32x16_bf16 v[80:95], v[28:31], v[16:19], v[80:95]
    ds_read_b64_tr_b16 v[52:53], v9 offset:36864
    ds_read_b64_tr_b16 v[54:55], v9 offset:37888
    v_mfma_f32_32x32x16_bf16 v[144:159], v[28:31], v[20:23], v[144:159]
    ds_read_b64_tr_b16 v[56:57], v10 offset:36864
    ds_read_b64_tr_b16 v[58:59], v10 offset:37888
    v_mfma_f32_32x32x16_bf16 v[96:111], v[32:35], v[16:19], v[96:111]
    ds_read_b64_tr_b16 v[60:61], v11 offset:36864
    ds_read_b64_tr_b16 v[62:63], v11 offset:37888
    v_mfma_f32_32x32x16_bf16 v[160:175], v[32:35], v[20:23], v[160:175]
    v_mfma_f32_32x32x16_bf16 v[112:127], v[36:39], v[16:19], v[112:127]
    v_mfma_f32_32x32x16_bf16 v[176:191], v[36:39], v[20:23], v[176:191]
    s_waitcnt vmcnt(4) lgkmcnt(0)
    s_barrier
    v_mfma_f32_32x32x16_bf16 v[64:79], v[48:51], v[40:43], v[64:79]
    ds_read_b128 v[16:19], v4 offset:0
    ds_read_b64_tr_b16 v[24:25], v8 offset:0
    s_cmp_ge_u32 s26, 7
    s_cselect_b32 s42, 1, 0
    s_mul_i32 s43, s42, 7
    s_sub_u32 s43, s26, s43
    s_lshl_b32 s50, s25, 1
    s_add_u32 s50, s50, s42
    s_mov_b32 s8, s48
    v_mfma_f32_32x32x16_bf16 v[128:143], v[48:51], v[44:47], v[128:143]
    ds_read_b64_tr_b16 v[26:27], v8 offset:1024
    ds_read_b128 v[20:23], v4 offset:4096
    s_mov_b32 s9, s49
    s_mov_b32 s10, 1605632
    s_lshl_b32 s36, s24, 11
    v_lshrrev_b32 v14, 3, v0
    v_bfe_u32 v15, v0, 4, 1
    v_lshlrev_b32 v15, 2, v15
    v_and_b32 v13, 7, v0
    v_mfma_f32_32x32x16_bf16 v[80:95], v[52:55], v[40:43], v[80:95]
    ds_read_b64_tr_b16 v[28:29], v9 offset:0
    ds_read_b64_tr_b16 v[30:31], v9 offset:1024
    v_xor_b32 v13, v13, v15
    v_lshlrev_b32 v13, 4, v13
    v_mov_b32 v15, 896
    v_mad_u32_u24 v1, v14, v15, v13
    v_lshl_add_u32 v2, v14, 12, v13
    s_lshl_b32 s51, s43, 7
    s_mul_i32 s83, s24, 57344
    v_mfma_f32_32x32x16_bf16 v[144:159], v[52:55], v[44:47], v[144:159]
    ds_read_b64_tr_b16 v[32:33], v10 offset:0
    ds_read_b64_tr_b16 v[34:35], v10 offset:1024
    s_add_u32 s83, s83, s51
    s_add_u32 s82, s83, 1605632
    s_mul_i32 s34, s85, 229376
    s_add_u32 s34, s34, s83
    v_add_u32 v252, 6144, v1
    v_add_u32 v253, 14336, v1
    v_add_u32 v254, 20480, v1
    v_mfma_f32_32x32x16_bf16 v[96:111], v[56:59], v[40:43], v[96:111]
    ds_read_b64_tr_b16 v[36:37], v11 offset:0
    ds_read_b64_tr_b16 v[38:39], v11 offset:1024
    s_add_u32 m0, s36, 32768
    s_nop 0
    buffer_load_dwordx4 v1, s[8:11], s34 offen lds
    v_mfma_f32_32x32x16_bf16 v[160:175], v[56:59], v[44:47], v[160:175]
    buffer_load_dwordx4 v252, s[8:11], s34 offen offset:1024 lds
    v_mfma_f32_32x32x16_bf16 v[112:127], v[60:63], v[40:43], v[112:127]
    s_add_u32 m0, s36, 40960
    s_nop 0
    buffer_load_dwordx4 v253, s[8:11], s34 offen lds
    v_mfma_f32_32x32x16_bf16 v[176:191], v[60:63], v[44:47], v[176:191]
    buffer_load_dwordx4 v254, s[8:11], s34 offen offset:1024 lds
    s_waitcnt lgkmcnt(0)
    v_mfma_f32_32x32x16_bf16 v[64:79], v[24:27], v[16:19], v[64:79]
    ds_read_b128 v[40:43], v5 offset:0
    ds_read_b64_tr_b16 v[48:49], v8 offset:4096
    v_mfma_f32_32x32x16_bf16 v[128:143], v[24:27], v[20:23], v[128:143]
    ds_read_b64_tr_b16 v[50:51], v8 offset:5120
    ds_read_b128 v[44:47], v5 offset:4096
    v_mfma_f32_32x32x16_bf16 v[80:95], v[28:31], v[16:19], v[80:95]
    ds_read_b64_tr_b16 v[52:53], v9 offset:4096
    ds_read_b64_tr_b16 v[54:55], v9 offset:5120
    v_mfma_f32_32x32x16_bf16 v[144:159], v[28:31], v[20:23], v[144:159]
    ds_read_b64_tr_b16 v[56:57], v10 offset:4096
    ds_read_b64_tr_b16 v[58:59], v10 offset:5120
    v_mfma_f32_32x32x16_bf16 v[96:111], v[32:35], v[16:19], v[96:111]
    ds_read_b64_tr_b16 v[60:61], v11 offset:4096
    ds_read_b64_tr_b16 v[62:63], v11 offset:5120
    s_add_u32 s34, s34, 229376
    s_cmp_ge_u32 s34, s82
    s_cselect_b32 s34, s83, s34
    s_add_u32 m0, s36, 65536
    s_nop 0
    buffer_load_dwordx4 v1, s[8:11], s34 offen lds
    v_mfma_f32_32x32x16_bf16 v[160:175], v[32:35], v[20:23], v[160:175]
    buffer_load_dwordx4 v252, s[8:11], s34 offen offset:1024 lds
    v_mfma_f32_32x32x16_bf16 v[112:127], v[36:39], v[16:19], v[112:127]
    s_add_u32 m0, s36, 73728
    s_nop 0
    buffer_load_dwordx4 v253, s[8:11], s34 offen lds
    v_mfma_f32_32x32x16_bf16 v[176:191], v[36:39], v[20:23], v[176:191]
    buffer_load_dwordx4 v254, s[8:11], s34 offen offset:1024 lds
    s_waitcnt vmcnt(8) lgkmcnt(0)
    s_barrier
    v_mfma_f32_32x32x16_bf16 v[64:79], v[48:51], v[40:43], v[64:79]
    ds_read_b128 v[16:19], v6 offset:0
    ds_read_b64_tr_b16 v[24:25], v8 offset:16384
    v_bfe_u32 v248, v0, 4, 1
    v_lshrrev_b32 v249, 5, v0
    v_bfe_u32 v250, v0, 2, 2
    v_and_b32 v251, 3, v0
    v_mfma_f32_32x32x16_bf16 v[128:143], v[48:51], v[44:47], v[128:143]
    ds_read_b64_tr_b16 v[26:27], v8 offset:17408
    ds_read_b128 v[20:23], v6 offset:4096
    v_lshl_add_u32 v15, v249, 2, v250
    v_lshlrev_b32 v15, 7, v15
    v_lshl_add_u32 v15, v251, 3, v15
    v_and_b32 v249, 2, v250
    v_mfma_f32_32x32x16_bf16 v[80:95], v[52:55], v[40:43], v[80:95]
    ds_read_b64_tr_b16 v[28:29], v9 offset:16384
    ds_read_b64_tr_b16 v[30:31], v9 offset:17408
    v_xor_b32 v249, v249, v248
    v_lshl_add_u32 v15, v249, 5, v15
    s_lshl_b32 s33, s32, 6
    v_xor_b32 v13, s33, v15
    v_mfma_f32_32x32x16_bf16 v[144:159], v[52:55], v[44:47], v[144:159]
    ds_read_b64_tr_b16 v[32:33], v10 offset:16384
    ds_read_b64_tr_b16 v[34:35], v10 offset:17408
    v_add_u32 v13, s36, v13
    v_xor_b32 v14, 64, v13
    v_add_u32 v3, 65536, v13
    v_mfma_f32_32x32x16_bf16 v[96:111], v[56:59], v[40:43], v[96:111]
    ds_read_b64_tr_b16 v[36:37], v11 offset:16384
    ds_read_b64_tr_b16 v[38:39], v11 offset:17408
    v_min_u32 v248, 13, v0
    v_and_b32 v249, 1, v248
    v_lshrrev_b32 v248, 1, v248
    v_mfma_f32_32x32x16_bf16 v[160:175], v[56:59], v[44:47], v[160:175]
    v_lshlrev_b32 v248, 10, v248
    v_lshl_add_u32 v248, v249, 4, v248
    s_lshl_b32 s33, s50, 5
    v_mfma_f32_32x32x16_bf16 v[112:127], v[60:63], v[40:43], v[112:127]
    s_add_u32 s33, s33, 16384
    v_add_u32 v248, s33, v248
    v_mov_b32 v249, 0
    v_mfma_f32_32x32x16_bf16 v[176:191], v[60:63], v[44:47], v[176:191]
    buffer_load_dwordx2 v[250:251], v249, s[44:47], 0 offen sc1
    s_waitcnt lgkmcnt(0)
    v_mfma_f32_32x32x16_bf16 v[64:79], v[24:27], v[16:19], v[64:79]
    ds_read_b128 v[40:43], v7 offset:0
    ds_read_b64_tr_b16 v[48:49], v8 offset:20480
    v_mfma_f32_32x32x16_bf16 v[128:143], v[24:27], v[20:23], v[128:143]
    ds_read_b64_tr_b16 v[50:51], v8 offset:21504
    ds_read_b128 v[44:47], v7 offset:4096
    v_mfma_f32_32x32x16_bf16 v[80:95], v[28:31], v[16:19], v[80:95]
    ds_read_b64_tr_b16 v[52:53], v9 offset:20480
    ds_read_b64_tr_b16 v[54:55], v9 offset:21504
    v_mfma_f32_32x32x16_bf16 v[144:159], v[28:31], v[20:23], v[144:159]
    ds_read_b64_tr_b16 v[56:57], v10 offset:20480
    ds_read_b64_tr_b16 v[58:59], v10 offset:21504
    v_mfma_f32_32x32x16_bf16 v[96:111], v[32:35], v[16:19], v[96:111]
    ds_read_b64_tr_b16 v[60:61], v11 offset:20480
    ds_read_b64_tr_b16 v[62:63], v11 offset:21504
    s_add_u32 s34, s34, 229376
    s_cmp_ge_u32 s34, s82
    s_cselect_b32 s34, s83, s34
    s_add_u32 m0, s36, 0
    s_nop 0
    buffer_load_dwordx4 v1, s[8:11], s34 offen lds
    v_mfma_f32_32x32x16_bf16 v[160:175], v[32:35], v[20:23], v[160:175]
    buffer_load_dwordx4 v252, s[8:11], s34 offen offset:1024 lds
    v_mfma_f32_32x32x16_bf16 v[112:127], v[36:39], v[16:19], v[112:127]
    s_add_u32 m0, s36, 8192
    s_nop 0
    buffer_load_dwordx4 v253, s[8:11], s34 offen lds
    v_mfma_f32_32x32x16_bf16 v[176:191], v[36:39], v[20:23], v[176:191]
    buffer_load_dwordx4 v254, s[8:11], s34 offen offset:1024 lds
    s_waitcnt lgkmcnt(0)
    s_barrier
    v_mfma_f32_32x32x16_bf16 v[64:79], v[48:51], v[40:43], v[64:79]
    s_mul_i32 s40, s50, 229376
    s_lshl_b32 s33, s24, 12
    s_add_u32 s40, s40, s33
    s_add_u32 s84, s40, 114688
    s_lshl_b32 s35, s85, 14
    v_mfma_f32_32x32x16_bf16 v[128:143], v[48:51], v[44:47], v[128:143]
    s_add_u32 s35, s35, s40
    s_mul_i32 s41, s27, 114688
    v_add_u32 v5, s41, v12
    s_xor_b32 s41, s41, 114688
    v_add_u32 v11, s41, v12
    s_add_u32 s34, s34, 229376
    s_cmp_ge_u32 s34, s82
    s_cselect_b32 s34, s83, s34
    s_add_u32 m0, s36, 16384
    s_nop 0
    buffer_load_dwordx4 v1, s[8:11], s34 offen lds
    v_mfma_f32_32x32x16_bf16 v[80:95], v[52:55], v[40:43], v[80:95]
    v_xor_b32 v8, 64, v3
    s_lshl_b32 s33, s27, 6
    v_xor_b32 v9, s33, v15
    s_lshl_b32 s33, s32, 12
    s_add_u32 s33, s33, 57344
    buffer_load_dwordx4 v252, s[8:11], s34 offen offset:1024 lds
    v_mfma_f32_32x32x16_bf16 v[144:159], v[52:55], v[44:47], v[144:159]
    v_add_u32 v9, s33, v9
    s_lshl_b32 s33, s25, 1
    s_add_u32 s33, s33, s27
    s_lshl_b32 s33, s33, 9
    s_lshl_b32 s38, s26, 1
    s_add_u32 m0, s36, 24576
    s_nop 0
    buffer_load_dwordx4 v253, s[8:11], s34 offen lds
    v_mfma_f32_32x32x16_bf16 v[96:111], v[56:59], v[40:43], v[96:111]
    s_add_u32 s38, s38, s32
    s_and_b32 s37, s38, 3
    s_lshl_b32 s37, s37, 7
    s_add_u32 s33, s33, s37
    s_lshr_b32 s38, s38, 2
    buffer_load_dwordx4 v254, s[8:11], s34 offen offset:1024 lds
    v_mfma_f32_32x32x16_bf16 v[160:175], v[56:59], v[44:47], v[160:175]
    s_lshl_b32 s38, s38, 3
    s_add_u32 s33, s33, s38
    v_mov_b32 v10, s33
    s_lshl_b32 s33, s50, 2
    s_add_u32 s33, s33, s24
    s_add_u32 s34, s34, 229376
    s_cmp_ge_u32 s34, s82
    s_cselect_b32 s34, s83, s34
    s_add_u32 m0, s36, 49152
    s_nop 0
    buffer_load_dwordx4 v1, s[8:11], s34 offen lds
    v_mfma_f32_32x32x16_bf16 v[112:127], v[60:63], v[40:43], v[112:127]
    s_lshl_b32 s33, s33, 7
    s_add_u32 s80, s56, s33
    s_addc_u32 s81, s57, 0
    v_lshlrev_b32 v7, 4, v0
    buffer_load_dwordx4 v252, s[8:11], s34 offen offset:1024 lds
    v_mfma_f32_32x32x16_bf16 v[176:191], v[60:63], v[44:47], v[176:191]
    s_lshl_b32 s33, s43, 10
    s_add_u32 s33, s33, 23552
    v_add_u32 v7, s33, v7
    v_and_b32 v4, 31, v0
    buffer_load_dwordx4 v[56:59], v248, s[56:59], 0 offen sc1
    s_setprio 3
    v_mov_b32 v28, 0xc0135761
    v_mov_b32 v29, 0xc0135761
    v_mov_b32 v30, 0xbdd2d3e8
    v_mov_b32 v31, 0xbdd2d3e8
    v_mov_b32 v44, 1.0
    v_mov_b32 v45, 1.0
    v_mul_f32 v16, v64, v64
    v_mul_f32 v17, v65, v65
    v_mul_f32 v18, v66, v66
    v_mul_f32 v19, v67, v67
    v_mul_f32 v20, v68, v68
    v_mul_f32 v21, v69, v69
    v_mul_f32 v22, v70, v70
    v_mul_f32 v23, v71, v71
    v_fmaak_f32 v16, v30, v16, 0xc0135761
    v_fmaak_f32 v17, v30, v17, 0xc0135761
    v_fmaak_f32 v18, v30, v18, 0xc0135761
    v_fmaak_f32 v19, v30, v19, 0xc0135761
    v_fmaak_f32 v20, v30, v20, 0xc0135761
    v_fmaak_f32 v21, v30, v21, 0xc0135761
    v_fmaak_f32 v22, v30, v22, 0xc0135761
    v_fmaak_f32 v23, v30, v23, 0xc0135761
    v_mul_f32 v16, v16, v64
    v_mul_f32 v17, v17, v65
    v_mul_f32 v18, v18, v66
    v_mul_f32 v19, v19, v67
    v_mul_f32 v20, v20, v68
    v_mul_f32 v21, v21, v69
    v_mul_f32 v22, v22, v70
    v_mul_f32 v23, v23, v71
    v_exp_f32 v16, v16
    v_exp_f32 v17, v17
    v_exp_f32 v18, v18
    v_exp_f32 v19, v19
    v_exp_f32 v20, v20
    v_exp_f32 v21, v21
    v_exp_f32 v22, v22
    v_exp_f32 v23, v23
    v_mul_f32 v64, v64, v72
    v_mul_f32 v65, v65, v73
    v_mul_f32 v66, v66, v74
    v_mul_f32 v67, v67, v75
    v_mul_f32 v68, v68, v76
    v_mul_f32 v69, v69, v77
    v_mul_f32 v70, v70, v78
    v_mul_f32 v71, v71, v79
    v_add_f32 v16, 1.0, v16
    v_add_f32 v17, 1.0, v17
    v_add_f32 v18, 1.0, v18
    v_add_f32 v19, 1.0, v19
    v_add_f32 v20, 1.0, v20
    v_add_f32 v21, 1.0, v21
    v_add_f32 v22, 1.0, v22
    v_add_f32 v23, 1.0, v23
    v_rcp_f32 v16, v16
    v_rcp_f32 v17, v17
    v_rcp_f32 v18, v18
    v_rcp_f32 v19, v19
    v_rcp_f32 v20, v20
    v_rcp_f32 v21, v21
    v_rcp_f32 v22, v22
    v_rcp_f32 v23, v23
    s_nop 0
    v_mul_f32 v64, v64, v16
    v_mul_f32 v65, v65, v17
    v_mul_f32 v66, v66, v18
    v_mul_f32 v67, v67, v19
    v_mul_f32 v68, v68, v20
    v_mul_f32 v69, v69, v21
    v_mul_f32 v70, v70, v22
    v_mul_f32 v71, v71, v23
    v_cvt_pk_bf16_f32 v24, v64, v65
    v_cvt_pk_bf16_f32 v25, v66, v67
    v_cvt_pk_bf16_f32 v26, v68, v69
    v_cvt_pk_bf16_f32 v27, v70, v71
    s_add_u32 s38, s39, 0
    buffer_store_dwordx4 v[24:27], v12, s[20:23], s38 offen sc1
    v_mul_f32 v32, v128, v128
    v_mul_f32 v33, v129, v129
    v_mul_f32 v34, v130, v130
    v_mul_f32 v35, v131, v131
    v_mul_f32 v36, v132, v132
    v_mul_f32 v37, v133, v133
    v_mul_f32 v38, v134, v134
    v_mul_f32 v39, v135, v135
    v_fmaak_f32 v32, v30, v32, 0xc0135761
    v_fmaak_f32 v33, v30, v33, 0xc0135761
    v_fmaak_f32 v34, v30, v34, 0xc0135761
    v_fmaak_f32 v35, v30, v35, 0xc0135761
    v_fmaak_f32 v36, v30, v36, 0xc0135761
    v_fmaak_f32 v37, v30, v37, 0xc0135761
    v_fmaak_f32 v38, v30, v38, 0xc0135761
    v_fmaak_f32 v39, v30, v39, 0xc0135761
    v_mul_f32 v32, v32, v128
    v_mul_f32 v33, v33, v129
    v_mul_f32 v34, v34, v130
    v_mul_f32 v35, v35, v131
    v_mul_f32 v36, v36, v132
    v_mul_f32 v37, v37, v133
    v_mul_f32 v38, v38, v134
    v_mul_f32 v39, v39, v135
    v_exp_f32 v32, v32
    v_exp_f32 v33, v33
    v_exp_f32 v34, v34
    v_exp_f32 v35, v35
    v_exp_f32 v36, v36
    v_exp_f32 v37, v37
    v_exp_f32 v38, v38
    v_exp_f32 v39, v39
    v_mul_f32 v128, v128, v136
    v_mul_f32 v129, v129, v137
    v_mul_f32 v130, v130, v138
    v_mul_f32 v131, v131, v139
    v_mul_f32 v132, v132, v140
    v_mul_f32 v133, v133, v141
    v_mul_f32 v134, v134, v142
    v_mul_f32 v135, v135, v143
    v_add_f32 v32, 1.0, v32
    v_add_f32 v33, 1.0, v33
    v_add_f32 v34, 1.0, v34
    v_add_f32 v35, 1.0, v35
    v_add_f32 v36, 1.0, v36
    v_add_f32 v37, 1.0, v37
    v_add_f32 v38, 1.0, v38
    v_add_f32 v39, 1.0, v39
    v_rcp_f32 v32, v32
    v_rcp_f32 v33, v33
    v_rcp_f32 v34, v34
    v_rcp_f32 v35, v35
    v_rcp_f32 v36, v36
    v_rcp_f32 v37, v37
    v_rcp_f32 v38, v38
    v_rcp_f32 v39, v39
    s_nop 0
    v_mul_f32 v128, v128, v32
    v_mul_f32 v129, v129, v33
    v_mul_f32 v130, v130, v34
    v_mul_f32 v131, v131, v35
    v_mul_f32 v132, v132, v36
    v_mul_f32 v133, v133, v37
    v_mul_f32 v134, v134, v38
    v_mul_f32 v135, v135, v39
    v_cvt_pk_bf16_f32 v40, v128, v129
    v_cvt_pk_bf16_f32 v41, v130, v131
    v_cvt_pk_bf16_f32 v42, v132, v133
    v_cvt_pk_bf16_f32 v43, v134, v135
    s_add_u32 s38, s39, 114688
    buffer_store_dwordx4 v[40:43], v12, s[20:23], s38 offen sc1
    s_waitcnt vmcnt(2)
    ds_read_b64_tr_b16 v[192:193], v13 offset:32768
    ds_read_b64_tr_b16 v[194:195], v13 offset:33792
    ds_read_b64_tr_b16 v[196:197], v14 offset:32768
    ds_read_b64_tr_b16 v[198:199], v14 offset:33792
    ds_read_b64_tr_b16 v[200:201], v13 offset:40960
    ds_read_b64_tr_b16 v[202:203], v13 offset:41984
    ds_read_b64_tr_b16 v[204:205], v14 offset:40960
    ds_read_b64_tr_b16 v[206:207], v14 offset:41984
    ds_read_b64_tr_b16 v[208:209], v3 offset:0
    ds_read_b64_tr_b16 v[210:211], v3 offset:1024
    ds_read_b64_tr_b16 v[212:213], v8 offset:0
    ds_read_b64_tr_b16 v[214:215], v8 offset:1024
    ds_read_b64_tr_b16 v[216:217], v3 offset:8192
    ds_read_b64_tr_b16 v[218:219], v3 offset:9216
    ds_read_b64_tr_b16 v[220:221], v8 offset:8192
    ds_read_b64_tr_b16 v[222:223], v8 offset:9216
    ds_read_b64_tr_b16 v[224:225], v13 offset:0
    ds_read_b64_tr_b16 v[226:227], v13 offset:1024
    ds_read_b64_tr_b16 v[228:229], v14 offset:0
    ds_read_b64_tr_b16 v[230:231], v14 offset:1024
    ds_read_b64_tr_b16 v[232:233], v13 offset:8192
    ds_read_b64_tr_b16 v[234:235], v13 offset:9216
    ds_read_b64_tr_b16 v[236:237], v14 offset:8192
    ds_read_b64_tr_b16 v[238:239], v14 offset:9216
    ds_read_b64_tr_b16 v[240:241], v13 offset:16384
    ds_read_b64_tr_b16 v[242:243], v13 offset:17408
    ds_read_b64_tr_b16 v[244:245], v14 offset:16384
    ds_read_b64_tr_b16 v[246:247], v14 offset:17408
    ds_read_b64_tr_b16 v[64:65], v13 offset:24576
    ds_read_b64_tr_b16 v[66:67], v13 offset:25600
    ds_read_b64_tr_b16 v[68:69], v14 offset:24576
    ds_read_b64_tr_b16 v[70:71], v14 offset:25600
    ds_read_b64_tr_b16 v[72:73], v13 offset:49152
    ds_read_b64_tr_b16 v[74:75], v13 offset:50176
    ds_read_b64_tr_b16 v[76:77], v14 offset:49152
    ds_read_b64_tr_b16 v[78:79], v14 offset:50176
    v_readfirstlane_b32 s96, v250
    v_readfirstlane_b32 s97, v251
    s_nop 3
    s_cmp_lg_u32 s96, 0
    s_cbranch_scc1 FG_havetag
    s_mov_b32 s98, 65536
    v_mov_b32 v62, 0
FG_nl:
    buffer_load_dwordx2 v[60:61], v62, s[44:47], 0 offen sc1
    s_waitcnt vmcnt(0)
    v_readfirstlane_b32 s96, v60
    v_readfirstlane_b32 s97, v61
    s_sub_u32 s98, s98, 1
    s_cbranch_scc1 FG_nd
    s_cmp_eq_u32 s96, 0
    s_cbranch_scc0 FG_nd
    s_sleep 2
    s_branch FG_nl
FG_nd:
FG_havetag:
    v_mov_b32 v50, s96
    v_mov_b32 v51, s97
    s_mov_b32 s99, 65536
    s_branch FGU_pc
FGU_pl:
    buffer_load_dwordx4 v[56:59], v248, s[56:59], 0 offen sc1
    s_waitcnt vmcnt(0)
FGU_pc:
    v_cmp_ne_u64 vcc, s[96:97], v[56:57]
    v_cmp_ne_u64 s[100:101], s[96:97], v[58:59]
    s_sub_u32 s99, s99, 1
    s_cbranch_scc1 FGU_pd
    s_or_b64 vcc, vcc, s[100:101]
    s_cbranch_scc0 FGU_pd
    s_sleep 8
    s_branch FGU_pl
FGU_pd:
    v_lshlrev_b32 v249, 5, v4
    s_lshl_b32 s33, s50, 1
    s_add_u32 s33, s33, s27
    s_lshl_b32 s33, s33, 10
    s_add_u32 s16, s6, 12582912
    s_addc_u32 s17, s7, 0
    s_mov_b32 s18, 65536
    s_mov_b32 s19, 0x00020000
    buffer_load_dwordx4 v[56:59], v249, s[16:19], s33 offen
    buffer_load_dwordx3 v[60:62], v249, s[16:19], s33 offen offset:16
    v_mul_f32 v16, v80, v80
    v_mul_f32 v17, v81, v81
    v_mul_f32 v18, v82, v82
    v_mul_f32 v19, v83, v83
    v_mul_f32 v20, v84, v84
    v_mul_f32 v21, v85, v85
    v_mul_f32 v22, v86, v86
    v_mul_f32 v23, v87, v87
    v_fmaak_f32 v16, v30, v16, 0xc0135761
    v_fmaak_f32 v17, v30, v17, 0xc0135761
    v_fmaak_f32 v18, v30, v18, 0xc0135761
    v_fmaak_f32 v19, v30, v19, 0xc0135761
    v_fmaak_f32 v20, v30, v20, 0xc0135761
    v_fmaak_f32 v21, v30, v21, 0xc0135761
    v_fmaak_f32 v22, v30, v22, 0xc0135761
    v_fmaak_f32 v23, v30, v23, 0xc0135761
    v_mul_f32 v16, v16, v80
    v_mul_f32 v17, v17, v81
    v_mul_f32 v18, v18, v82
    v_mul_f32 v19, v19, v83
    v_mul_f32 v20, v20, v84
    v_mul_f32 v21, v21, v85
    v_mul_f32 v22, v22, v86
    v_mul_f32 v23, v23, v87
    v_exp_f32 v16, v16
    v_exp_f32 v17, v17
    v_exp_f32 v18, v18
    v_exp_f32 v19, v19
    v_exp_f32 v20, v20
    v_exp_f32 v21, v21
    v_exp_f32 v22, v22
    v_exp_f32 v23, v23
    v_mul_f32 v80, v80, v88
    v_mul_f32 v81, v81, v89
    v_mul_f32 v82, v82, v90
    v_mul_f32 v83, v83, v91
    v_mul_f32 v84, v84, v92
    v_mul_f32 v85, v85, v93
    v_mul_f32 v86, v86, v94
    v_mul_f32 v87, v87, v95
    v_add_f32 v16, 1.0, v16
    v_add_f32 v17, 1.0, v17
    v_add_f32 v18, 1.0, v18
    v_add_f32 v19, 1.0, v19
    v_add_f32 v20, 1.0, v20
    v_add_f32 v21, 1.0, v21
    v_add_f32 v22, 1.0, v22
    v_add_f32 v23, 1.0, v23
    v_rcp_f32 v16, v16
    v_rcp_f32 v17, v17
    v_rcp_f32 v18, v18
    v_rcp_f32 v19, v19
    v_rcp_f32 v20, v20
    v_rcp_f32 v21, v21
    v_rcp_f32 v22, v22
    v_rcp_f32 v23, v23
    s_nop 0
    v_mul_f32 v80, v80, v16
    v_mul_f32 v81, v81, v17
    v_mul_f32 v82, v82, v18
    v_mul_f32 v83, v83, v19
    v_mul_f32 v84, v84, v20
    v_mul_f32 v85, v85, v21
    v_mul_f32 v86, v86, v22
    v_mul_f32 v87, v87, v23
    v_cvt_pk_bf16_f32 v24, v80, v81
    v_cvt_pk_bf16_f32 v25, v82, v83
    v_cvt_pk_bf16_f32 v26, v84, v85
    v_cvt_pk_bf16_f32 v27, v86, v87
    s_add_u32 s38, s39, 1024
    buffer_store_dwordx4 v[24:27], v12, s[20:23], s38 offen sc1
    s_waitcnt lgkmcnt(0)
    s_add_u32 m0, s36, 32768
    s_nop 0
    buffer_load_dwordx4 v253, s[8:11], s34 offen lds
    buffer_load_dwordx4 v254, s[8:11], s34 offen offset:1024 lds
    s_add_u32 s34, s34, 229376
    s_cmp_ge_u32 s34, s82
    s_cselect_b32 s34, s83, s34
    s_add_u32 m0, s36, 40960
    s_nop 0
    buffer_load_dwordx4 v1, s[8:11], s34 offen lds
    buffer_load_dwordx4 v252, s[8:11], s34 offen offset:1024 lds
    s_add_u32 m0, s36, 65536
    s_nop 0
    buffer_load_dwordx4 v253, s[8:11], s34 offen lds
    buffer_load_dwordx4 v254, s[8:11], s34 offen offset:1024 lds
    v_mul_f32 v32, v144, v144
    v_mul_f32 v33, v145, v145
    v_mul_f32 v34, v146, v146
    v_mul_f32 v35, v147, v147
    v_mul_f32 v36, v148, v148
    v_mul_f32 v37, v149, v149
    v_mul_f32 v38, v150, v150
    v_mul_f32 v39, v151, v151
    v_fmaak_f32 v32, v30, v32, 0xc0135761
    v_fmaak_f32 v33, v30, v33, 0xc0135761
    v_fmaak_f32 v34, v30, v34, 0xc0135761
    v_fmaak_f32 v35, v30, v35, 0xc0135761
    v_fmaak_f32 v36, v30, v36, 0xc0135761
    v_fmaak_f32 v37, v30, v37, 0xc0135761
    v_fmaak_f32 v38, v30, v38, 0xc0135761
    v_fmaak_f32 v39, v30, v39, 0xc0135761
    v_mul_f32 v32, v32, v144
    v_mul_f32 v33, v33, v145
    v_mul_f32 v34, v34, v146
    v_mul_f32 v35, v35, v147
    v_mul_f32 v36, v36, v148
    v_mul_f32 v37, v37, v149
    v_mul_f32 v38, v38, v150
    v_mul_f32 v39, v39, v151
    v_exp_f32 v32, v32
    v_exp_f32 v33, v33
    v_exp_f32 v34, v34
    v_exp_f32 v35, v35
    v_exp_f32 v36, v36
    v_exp_f32 v37, v37
    v_exp_f32 v38, v38
    v_exp_f32 v39, v39
    v_mul_f32 v144, v144, v152
    v_mul_f32 v145, v145, v153
    v_mul_f32 v146, v146, v154
    v_mul_f32 v147, v147, v155
    v_mul_f32 v148, v148, v156
    v_mul_f32 v149, v149, v157
    v_mul_f32 v150, v150, v158
    v_mul_f32 v151, v151, v159
    v_add_f32 v32, 1.0, v32
    v_add_f32 v33, 1.0, v33
    v_add_f32 v34, 1.0, v34
    v_add_f32 v35, 1.0, v35
    v_add_f32 v36, 1.0, v36
    v_add_f32 v37, 1.0, v37
    v_add_f32 v38, 1.0, v38
    v_add_f32 v39, 1.0, v39
    v_rcp_f32 v32, v32
    v_rcp_f32 v33, v33
    v_rcp_f32 v34, v34
    v_rcp_f32 v35, v35
    v_rcp_f32 v36, v36
    v_rcp_f32 v37, v37
    v_rcp_f32 v38, v38
    v_rcp_f32 v39, v39
    s_nop 0
    v_mul_f32 v144, v144, v32
    v_mul_f32 v145, v145, v33
    v_mul_f32 v146, v146, v34
    v_mul_f32 v147, v147, v35
    v_mul_f32 v148, v148, v36
    v_mul_f32 v149, v149, v37
    v_mul_f32 v150, v150, v38
    v_mul_f32 v151, v151, v39
    v_cvt_pk_bf16_f32 v40, v144, v145
    v_cvt_pk_bf16_f32 v41, v146, v147
    v_cvt_pk_bf16_f32 v42, v148, v149
    v_cvt_pk_bf16_f32 v43, v150, v151
    s_add_u32 s38, s39, 115712
    buffer_store_dwordx4 v[40:43], v12, s[20:23], s38 offen sc1
    s_add_u32 s34, s34, 229376
    s_cmp_ge_u32 s34, s82
    s_cselect_b32 s34, s83, s34
    s_add_u32 m0, s36, 73728
    s_nop 0
    buffer_load_dwordx4 v1, s[8:11], s34 offen lds
    buffer_load_dwordx4 v252, s[8:11], s34 offen offset:1024 lds
    s_add_u32 m0, s36, 0
    s_nop 0
    buffer_load_dwordx4 v253, s[8:11], s34 offen lds
    buffer_load_dwordx4 v254, s[8:11], s34 offen offset:1024 lds
    s_add_u32 s34, s34, 229376
    s_cmp_ge_u32 s34, s82
    s_cselect_b32 s34, s83, s34
    s_add_u32 s34, s34, 28672
    s_add_u32 s82, s82, 28672
    s_add_u32 s83, s83, 28672
    s_add_u32 m0, s36, 8192
    s_nop 0
    buffer_load_dwordx4 v1, s[8:11], s34 offen lds
    buffer_load_dwordx4 v252, s[8:11], s34 offen offset:1024 lds
    v_mul_f32 v16, v96, v96
    v_mul_f32 v17, v97, v97
    v_mul_f32 v18, v98, v98
    v_mul_f32 v19, v99, v99
    v_mul_f32 v20, v100, v100
    v_mul_f32 v21, v101, v101
    v_mul_f32 v22, v102, v102
    v_mul_f32 v23, v103, v103
    v_fmaak_f32 v16, v30, v16, 0xc0135761
    v_fmaak_f32 v17, v30, v17, 0xc0135761
    v_fmaak_f32 v18, v30, v18, 0xc0135761
    v_fmaak_f32 v19, v30, v19, 0xc0135761
    v_fmaak_f32 v20, v30, v20, 0xc0135761
    v_fmaak_f32 v21, v30, v21, 0xc0135761
    v_fmaak_f32 v22, v30, v22, 0xc0135761
    v_fmaak_f32 v23, v30, v23, 0xc0135761
    v_mul_f32 v16, v16, v96
    v_mul_f32 v17, v17, v97
    v_mul_f32 v18, v18, v98
    v_mul_f32 v19, v19, v99
    v_mul_f32 v20, v20, v100
    v_mul_f32 v21, v21, v101
    v_mul_f32 v22, v22, v102
    v_mul_f32 v23, v23, v103
    v_exp_f32 v16, v16
    v_exp_f32 v17, v17
    v_exp_f32 v18, v18
    v_exp_f32 v19, v19
    v_exp_f32 v20, v20
    v_exp_f32 v21, v21
    v_exp_f32 v22, v22
    v_exp_f32 v23, v23
    v_mul_f32 v96, v96, v104
    v_mul_f32 v97, v97, v105
    v_mul_f32 v98, v98, v106
    v_mul_f32 v99, v99, v107
    v_mul_f32 v100, v100, v108
    v_mul_f32 v101, v101, v109
    v_mul_f32 v102, v102, v110
    v_mul_f32 v103, v103, v111
    v_add_f32 v16, 1.0, v16
    v_add_f32 v17, 1.0, v17
    v_add_f32 v18, 1.0, v18
    v_add_f32 v19, 1.0, v19
    v_add_f32 v20, 1.0, v20
    v_add_f32 v21, 1.0, v21
    v_add_f32 v22, 1.0, v22
    v_add_f32 v23, 1.0, v23
    v_rcp_f32 v16, v16
    v_rcp_f32 v17, v17
    v_rcp_f32 v18, v18
    v_rcp_f32 v19, v19
    v_rcp_f32 v20, v20
    v_rcp_f32 v21, v21
    v_rcp_f32 v22, v22
    v_rcp_f32 v23, v23
    s_nop 0
    v_mul_f32 v96, v96, v16
    v_mul_f32 v97, v97, v17
    v_mul_f32 v98, v98, v18
    v_mul_f32 v99, v99, v19
    v_mul_f32 v100, v100, v20
    v_mul_f32 v101, v101, v21
    v_mul_f32 v102, v102, v22
    v_mul_f32 v103, v103, v23
    v_cvt_pk_bf16_f32 v24, v96, v97
    v_cvt_pk_bf16_f32 v25, v98, v99
    v_cvt_pk_bf16_f32 v26, v100, v101
    v_cvt_pk_bf16_f32 v27, v102, v103
    s_add_u32 s38, s39, 2048
    buffer_store_dwordx4 v[24:27], v12, s[20:23], s38 offen sc1
    s_add_u32 m0, s36, 16384
    s_nop 0
    buffer_load_dwordx4 v253, s[8:11], s34 offen lds
    buffer_load_dwordx4 v254, s[8:11], s34 offen offset:1024 lds
    s_add_u32 s34, s34, 229376
    s_cmp_ge_u32 s34, s82
    s_cselect_b32 s34, s83, s34
    s_add_u32 m0, s36, 24576
    s_nop 0
    buffer_load_dwordx4 v1, s[8:11], s34 offen lds
    buffer_load_dwordx4 v252, s[8:11], s34 offen offset:1024 lds
    s_add_u32 m0, s36, 49152
    s_nop 0
    buffer_load_dwordx4 v253, s[8:11], s34 offen lds
    buffer_load_dwordx4 v254, s[8:11], s34 offen offset:1024 lds
    v_mul_f32 v32, v160, v160
    v_mul_f32 v33, v161, v161
    v_mul_f32 v34, v162, v162
    v_mul_f32 v35, v163, v163
    v_mul_f32 v36, v164, v164
    v_mul_f32 v37, v165, v165
    v_mul_f32 v38, v166, v166
    v_mul_f32 v39, v167, v167
    v_fmaak_f32 v32, v30, v32, 0xc0135761
    v_fmaak_f32 v33, v30, v33, 0xc0135761
    v_fmaak_f32 v34, v30, v34, 0xc0135761
    v_fmaak_f32 v35, v30, v35, 0xc0135761
    v_fmaak_f32 v36, v30, v36, 0xc0135761
    v_fmaak_f32 v37, v30, v37, 0xc0135761
    v_fmaak_f32 v38, v30, v38, 0xc0135761
    v_fmaak_f32 v39, v30, v39, 0xc0135761
    v_mul_f32 v32, v32, v160
    v_mul_f32 v33, v33, v161
    v_mul_f32 v34, v34, v162
    v_mul_f32 v35, v35, v163
    v_mul_f32 v36, v36, v164
    v_mul_f32 v37, v37, v165
    v_mul_f32 v38, v38, v166
    v_mul_f32 v39, v39, v167
    v_exp_f32 v32, v32
    v_exp_f32 v33, v33
    v_exp_f32 v34, v34
    v_exp_f32 v35, v35
    v_exp_f32 v36, v36
    v_exp_f32 v37, v37
    v_exp_f32 v38, v38
    v_exp_f32 v39, v39
    v_mul_f32 v160, v160, v168
    v_mul_f32 v161, v161, v169
    v_mul_f32 v162, v162, v170
    v_mul_f32 v163, v163, v171
    v_mul_f32 v164, v164, v172
    v_mul_f32 v165, v165, v173
    v_mul_f32 v166, v166, v174
    v_mul_f32 v167, v167, v175
    v_add_f32 v32, 1.0, v32
    v_add_f32 v33, 1.0, v33
    v_add_f32 v34, 1.0, v34
    v_add_f32 v35, 1.0, v35
    v_add_f32 v36, 1.0, v36
    v_add_f32 v37, 1.0, v37
    v_add_f32 v38, 1.0, v38
    v_add_f32 v39, 1.0, v39
    v_rcp_f32 v32, v32
    v_rcp_f32 v33, v33
    v_rcp_f32 v34, v34
    v_rcp_f32 v35, v35
    v_rcp_f32 v36, v36
    v_rcp_f32 v37, v37
    v_rcp_f32 v38, v38
    v_rcp_f32 v39, v39
    s_nop 0
    v_mul_f32 v160, v160, v32
    v_mul_f32 v161, v161, v33
    v_mul_f32 v162, v162, v34
    v_mul_f32 v163, v163, v35
    v_mul_f32 v164, v164, v36
    v_mul_f32 v165, v165, v37
    v_mul_f32 v166, v166, v38
    v_mul_f32 v167, v167, v39
    v_cvt_pk_bf16_f32 v40, v160, v161
    v_cvt_pk_bf16_f32 v41, v162, v163
    v_cvt_pk_bf16_f32 v42, v164, v165
    v_cvt_pk_bf16_f32 v43, v166, v167
    s_add_u32 s38, s39, 116736
    buffer_store_dwordx4 v[40:43], v12, s[20:23], s38 offen sc1
    v_mul_f32 v16, v112, v112
    v_mul_f32 v17, v113, v113
    v_mul_f32 v18, v114, v114
    v_mul_f32 v19, v115, v115
    v_mul_f32 v20, v116, v116
    v_mul_f32 v21, v117, v117
    v_mul_f32 v22, v118, v118
    v_mul_f32 v23, v119, v119
    v_fmaak_f32 v16, v30, v16, 0xc0135761
    v_fmaak_f32 v17, v30, v17, 0xc0135761
    v_fmaak_f32 v18, v30, v18, 0xc0135761
    v_fmaak_f32 v19, v30, v19, 0xc0135761
    v_fmaak_f32 v20, v30, v20, 0xc0135761
    v_fmaak_f32 v21, v30, v21, 0xc0135761
    v_fmaak_f32 v22, v30, v22, 0xc0135761
    v_fmaak_f32 v23, v30, v23, 0xc0135761
    v_mul_f32 v16, v16, v112
    v_mul_f32 v17, v17, v113
    v_mul_f32 v18, v18, v114
    v_mul_f32 v19, v19, v115
    v_mul_f32 v20, v20, v116
    v_mul_f32 v21, v21, v117
    v_mul_f32 v22, v22, v118
    v_mul_f32 v23, v23, v119
    v_exp_f32 v16, v16
    v_exp_f32 v17, v17
    v_exp_f32 v18, v18
    v_exp_f32 v19, v19
    v_exp_f32 v20, v20
    v_exp_f32 v21, v21
    v_exp_f32 v22, v22
    v_exp_f32 v23, v23
    v_mul_f32 v112, v112, v120
    v_mul_f32 v113, v113, v121
    v_mul_f32 v114, v114, v122
    v_mul_f32 v115, v115, v123
    v_mul_f32 v116, v116, v124
    v_mul_f32 v117, v117, v125
    v_mul_f32 v118, v118, v126
    v_mul_f32 v119, v119, v127
    v_add_f32 v16, 1.0, v16
    v_add_f32 v17, 1.0, v17
    v_add_f32 v18, 1.0, v18
    v_add_f32 v19, 1.0, v19
    v_add_f32 v20, 1.0, v20
    v_add_f32 v21, 1.0, v21
    v_add_f32 v22, 1.0, v22
    v_add_f32 v23, 1.0, v23
    v_rcp_f32 v16, v16
    v_rcp_f32 v17, v17
    v_rcp_f32 v18, v18
    v_rcp_f32 v19, v19
    v_rcp_f32 v20, v20
    v_rcp_f32 v21, v21
    v_rcp_f32 v22, v22
    v_rcp_f32 v23, v23
    s_nop 0
    v_mul_f32 v112, v112, v16
    v_mul_f32 v113, v113, v17
    v_mul_f32 v114, v114, v18
    v_mul_f32 v115, v115, v19
    v_mul_f32 v116, v116, v20
    v_mul_f32 v117, v117, v21
    v_mul_f32 v118, v118, v22
    v_mul_f32 v119, v119, v23
    v_cvt_pk_bf16_f32 v24, v112, v113
    v_cvt_pk_bf16_f32 v25, v114, v115
    v_cvt_pk_bf16_f32 v26, v116, v117
    v_cvt_pk_bf16_f32 v27, v118, v119
    s_add_u32 s38, s39, 3072
    buffer_store_dwordx4 v[24:27], v12, s[20:23], s38 offen sc1
    s_waitcnt vmcnt(6)
    s_mov_b64 exec, 1
    buffer_store_dwordx2 v[50:51], v10, s[56:59], 0 offen offset:0 sc1
    s_mov_b64 exec, -1
    ds_read_b64_tr_b16 v[128:129], v13 offset:32768
    ds_read_b64_tr_b16 v[130:131], v13 offset:33792
    ds_read_b64_tr_b16 v[132:133], v14 offset:32768
    ds_read_b64_tr_b16 v[134:135], v14 offset:33792
    ds_read_b64_tr_b16 v[136:137], v13 offset:40960
    ds_read_b64_tr_b16 v[138:139], v13 offset:41984
    ds_read_b64_tr_b16 v[140:141], v14 offset:40960
    ds_read_b64_tr_b16 v[142:143], v14 offset:41984
    ds_read_b64_tr_b16 v[80:81], v3 offset:0
    ds_read_b64_tr_b16 v[82:83], v3 offset:1024
    ds_read_b64_tr_b16 v[84:85], v8 offset:0
    ds_read_b64_tr_b16 v[86:87], v8 offset:1024
    ds_read_b64_tr_b16 v[88:89], v3 offset:8192
    ds_read_b64_tr_b16 v[90:91], v3 offset:9216
    ds_read_b64_tr_b16 v[92:93], v8 offset:8192
    ds_read_b64_tr_b16 v[94:95], v8 offset:9216
    ds_read_b64_tr_b16 v[144:145], v13 offset:0
    ds_read_b64_tr_b16 v[146:147], v13 offset:1024
    ds_read_b64_tr_b16 v[148:149], v14 offset:0
    ds_read_b64_tr_b16 v[150:151], v14 offset:1024
    ds_read_b64_tr_b16 v[152:153], v13 offset:8192
    ds_read_b64_tr_b16 v[154:155], v13 offset:9216
    ds_read_b64_tr_b16 v[156:157], v14 offset:8192
    ds_read_b64_tr_b16 v[158:159], v14 offset:9216
    ds_read_b64_tr_b16 v[96:97], v13 offset:16384
    ds_read_b64_tr_b16 v[98:99], v13 offset:17408
    ds_read_b64_tr_b16 v[100:101], v14 offset:16384
    ds_read_b64_tr_b16 v[102:103], v14 offset:17408
    v_mul_f32 v32, v176, v176
    v_mul_f32 v33, v177, v177
    v_mul_f32 v34, v178, v178
    v_mul_f32 v35, v179, v179
    v_mul_f32 v36, v180, v180
    v_mul_f32 v37, v181, v181
    v_mul_f32 v38, v182, v182
    v_mul_f32 v39, v183, v183
    v_fmaak_f32 v32, v30, v32, 0xc0135761
    v_fmaak_f32 v33, v30, v33, 0xc0135761
    v_fmaak_f32 v34, v30, v34, 0xc0135761
    v_fmaak_f32 v35, v30, v35, 0xc0135761
    v_fmaak_f32 v36, v30, v36, 0xc0135761
    v_fmaak_f32 v37, v30, v37, 0xc0135761
    v_fmaak_f32 v38, v30, v38, 0xc0135761
    v_fmaak_f32 v39, v30, v39, 0xc0135761
    v_mul_f32 v32, v32, v176
    v_mul_f32 v33, v33, v177
    v_mul_f32 v34, v34, v178
    v_mul_f32 v35, v35, v179
    v_mul_f32 v36, v36, v180
    v_mul_f32 v37, v37, v181
    v_mul_f32 v38, v38, v182
    v_mul_f32 v39, v39, v183
    v_exp_f32 v32, v32
    v_exp_f32 v33, v33
    v_exp_f32 v34, v34
    v_exp_f32 v35, v35
    v_exp_f32 v36, v36
    v_exp_f32 v37, v37
    v_exp_f32 v38, v38
    v_exp_f32 v39, v39
    v_mul_f32 v176, v176, v184
    v_mul_f32 v177, v177, v185
    v_mul_f32 v178, v178, v186
    v_mul_f32 v179, v179, v187
    v_mul_f32 v180, v180, v188
    v_mul_f32 v181, v181, v189
    v_mul_f32 v182, v182, v190
    v_mul_f32 v183, v183, v191
    v_add_f32 v32, 1.0, v32
    v_add_f32 v33, 1.0, v33
    v_add_f32 v34, 1.0, v34
    v_add_f32 v35, 1.0, v35
    v_add_f32 v36, 1.0, v36
    v_add_f32 v37, 1.0, v37
    v_add_f32 v38, 1.0, v38
    v_add_f32 v39, 1.0, v39
    v_rcp_f32 v32, v32
    v_rcp_f32 v33, v33
    v_rcp_f32 v34, v34
    v_rcp_f32 v35, v35
    v_rcp_f32 v36, v36
    v_rcp_f32 v37, v37
    v_rcp_f32 v38, v38
    v_rcp_f32 v39, v39
    s_nop 0
    v_mul_f32 v176, v176, v32
    v_mul_f32 v177, v177, v33
    v_mul_f32 v178, v178, v34
    v_mul_f32 v179, v179, v35
    v_mul_f32 v180, v180, v36
    v_mul_f32 v181, v181, v37
    v_mul_f32 v182, v182, v38
    v_mul_f32 v183, v183, v39
    v_cvt_pk_bf16_f32 v40, v176, v177
    v_cvt_pk_bf16_f32 v41, v178, v179
    v_cvt_pk_bf16_f32 v42, v180, v181
    v_cvt_pk_bf16_f32 v43, v182, v183
    s_add_u32 s38, s39, 117760
    buffer_store_dwordx4 v[40:43], v12, s[20:23], s38 offen sc1
    s_setprio 0
    v_add_f32 v56, v56, v57
    v_add_f32 v58, v58, v59
    v_add_f32 v60, v60, v61
    v_add_f32 v56, v56, v58
    v_add_f32 v60, v60, v62
    v_add_f32 v56, v56, v60
    v_cvt_pk_bf16_f32 v56, v56, v56
    v_lshlrev_b32 v56, 16, v56
    v_mul_f32 v56, 0xbfb8aa3b, v56
    v_exp_f32 v6, v56
    s_waitcnt lgkmcnt(0)
    s_load_dwordx16 s[64:79], s[80:81], 0 glc
    v_add_f32 v6, 1.0, v6
    v_rcp_f32 v6, v6
    s_add_u32 s12, s6, 10485760
    s_addc_u32 s13, s7, 0
    s_mov_b32 s14, 1835008
    s_mov_b32 s15, 0x00020000
    v_cvt_pk_bf16_f32 v6, v6, v6
    v_lshlrev_b32 v6, 16, v6
    s_mov_b32 s99, 65536
    s_branch FGH_pc
FGH_pl:
    s_load_dwordx16 s[64:79], s[80:81], 0 glc
FGH_pc:
    s_waitcnt lgkmcnt(0)
    s_sub_u32 s99, s99, 1
    s_cbranch_scc1 FGH_pd
    s_cmp_lg_u64 s[64:65], s[96:97]
    s_cbranch_scc1 FGH_pl
    s_cmp_lg_u64 s[66:67], s[96:97]
    s_cbranch_scc1 FGH_pl
    s_cmp_lg_u64 s[68:69], s[96:97]
    s_cbranch_scc1 FGH_pl
    s_cmp_lg_u64 s[70:71], s[96:97]
    s_cbranch_scc1 FGH_pl
    s_cmp_lg_u64 s[72:73], s[96:97]
    s_cbranch_scc1 FGH_pl
    s_cmp_lg_u64 s[74:75], s[96:97]
    s_cbranch_scc1 FGH_pl
    s_cmp_lg_u64 s[76:77], s[96:97]
    s_cbranch_scc1 FGH_pl
FGH_pd:
    buffer_load_dwordx4 v[104:107], v5, s[20:23], s35 offen offset:0
    buffer_load_dwordx4 v[108:111], v11, s[20:23], s35 offen offset:0
    buffer_load_dwordx4 v[160:163], v5, s[20:23], s35 offen offset:1024
    buffer_load_dwordx4 v[164:167], v11, s[20:23], s35 offen offset:1024
    s_add_u32 s35, s35, 16384
    s_cmp_ge_u32 s35, s84
    s_cselect_b32 s35, s40, s35
    buffer_load_dwordx4 v[168:171], v5, s[20:23], s35 offen offset:0
    buffer_load_dwordx4 v[172:175], v11, s[20:23], s35 offen offset:0
    buffer_load_dwordx4 v[112:115], v5, s[20:23], s35 offen offset:1024
    buffer_load_dwordx4 v[116:119], v11, s[20:23], s35 offen offset:1024
    s_waitcnt vmcnt(6)
    s_mov_b64 exec, 1
    buffer_store_dwordx2 v[50:51], v10, s[56:59], 0 offen offset:64 sc1
    s_mov_b64 exec, -1
    v_mfma_f32_32x32x16_bf16 v[16:31], v[192:195], v[104:107], 0
    s_add_u32 s35, s35, 16384
    s_cmp_ge_u32 s35, s84
    s_cselect_b32 s35, s40, s35
    buffer_load_dwordx4 v[120:123], v5, s[20:23], s35 offen offset:0
    v_mfma_f32_32x32x16_bf16 v[32:47], v[192:195], v[108:111], 0
    buffer_load_dwordx4 v[124:127], v11, s[20:23], s35 offen offset:0
    v_mfma_f32_32x32x16_bf16 v[48:63], v[196:199], v[104:107], 0
    v_mfma_f32_32x32x16_bf16 v[176:191], v[196:199], v[108:111], 0
    s_waitcnt vmcnt(7)
    v_mfma_f32_32x32x16_bf16 v[16:31], v[200:203], v[160:163], v[16:31]
    buffer_load_dwordx4 v[104:107], v5, s[20:23], s35 offen offset:1024
    v_mfma_f32_32x32x16_bf16 v[32:47], v[200:203], v[164:167], v[32:47]
    buffer_load_dwordx4 v[108:111], v11, s[20:23], s35 offen offset:1024
    v_mfma_f32_32x32x16_bf16 v[48:63], v[204:207], v[160:163], v[48:63]
    v_mfma_f32_32x32x16_bf16 v[176:191], v[204:207], v[164:167], v[176:191]
    s_waitcnt vmcnt(7)
    v_mfma_f32_32x32x16_bf16 v[16:31], v[208:211], v[168:171], v[16:31]
    s_add_u32 s35, s35, 16384
    s_cmp_ge_u32 s35, s84
    s_cselect_b32 s35, s40, s35
    buffer_load_dwordx4 v[160:163], v5, s[20:23], s35 offen offset:0
    v_mfma_f32_32x32x16_bf16 v[32:47], v[208:211], v[172:175], v[32:47]
    buffer_load_dwordx4 v[164:167], v11, s[20:23], s35 offen offset:0
    v_mfma_f32_32x32x16_bf16 v[48:63], v[212:215], v[168:171], v[48:63]
    v_mfma_f32_32x32x16_bf16 v[176:191], v[212:215], v[172:175], v[176:191]
    s_waitcnt vmcnt(7)
    v_mfma_f32_32x32x16_bf16 v[16:31], v[216:219], v[112:115], v[16:31]
    buffer_load_dwordx4 v[168:171], v5, s[20:23], s35 offen offset:1024
    v_mfma_f32_32x32x16_bf16 v[32:47], v[216:219], v[116:119], v[32:47]
    buffer_load_dwordx4 v[172:175], v11, s[20:23], s35 offen offset:1024
    v_mfma_f32_32x32x16_bf16 v[48:63], v[220:223], v[112:115], v[48:63]
    s_add_u32 s34, s34, 229376
    s_cmp_ge_u32 s34, s82
    s_cselect_b32 s34, s83, s34
    s_add_u32 m0, s36, 32768
    s_nop 0
    buffer_load_dwordx4 v1, s[8:11], s34 offen lds
    v_mfma_f32_32x32x16_bf16 v[176:191], v[220:223], v[116:119], v[176:191]
    buffer_load_dwordx4 v252, s[8:11], s34 offen offset:1024 lds
    s_waitcnt vmcnt(8)
    v_mfma_f32_32x32x16_bf16 v[16:31], v[224:227], v[120:123], v[16:31]
    s_add_u32 s35, s35, 16384
    s_cmp_ge_u32 s35, s84
    s_cselect_b32 s35, s40, s35
    buffer_load_dwordx4 v[112:115], v5, s[20:23], s35 offen offset:0
    v_mfma_f32_32x32x16_bf16 v[32:47], v[224:227], v[124:127], v[32:47]
    buffer_load_dwordx4 v[116:119], v11, s[20:23], s35 offen offset:0
    v_mfma_f32_32x32x16_bf16 v[48:63], v[228:231], v[120:123], v[48:63]
    s_add_u32 m0, s36, 40960
    s_nop 0
    buffer_load_dwordx4 v253, s[8:11], s34 offen lds
    v_mfma_f32_32x32x16_bf16 v[176:191], v[228:231], v[124:127], v[176:191]
    buffer_load_dwordx4 v254, s[8:11], s34 offen offset:1024 lds
    s_waitcnt vmcnt(10)
    v_mfma_f32_32x32x16_bf16 v[16:31], v[232:235], v[104:107], v[16:31]
    buffer_load_dwordx4 v[120:123], v5, s[20:23], s35 offen offset:1024
    v_mfma_f32_32x32x16_bf16 v[32:47], v[232:235], v[108:111], v[32:47]
    buffer_load_dwordx4 v[124:127], v11, s[20:23], s35 offen offset:1024
    v_mfma_f32_32x32x16_bf16 v[48:63], v[236:239], v[104:107], v[48:63]
    s_add_u32 s34, s34, 229376
    s_cmp_ge_u32 s34, s82
    s_cselect_b32 s34, s83, s34
    s_add_u32 m0, s36, 65536
    s_nop 0
    buffer_load_dwordx4 v1, s[8:11], s34 offen lds
    v_mfma_f32_32x32x16_bf16 v[176:191], v[236:239], v[108:111], v[176:191]
    buffer_load_dwordx4 v252, s[8:11], s34 offen offset:1024 lds
    s_waitcnt vmcnt(12)
    v_mfma_f32_32x32x16_bf16 v[16:31], v[240:243], v[160:163], v[16:31]
    s_add_u32 s35, s35, 16384
    s_cmp_ge_u32 s35, s84
    s_cselect_b32 s35, s40, s35
    buffer_load_dwordx4 v[104:107], v5, s[20:23], s35 offen offset:0
    v_mfma_f32_32x32x16_bf16 v[32:47], v[240:243], v[164:167], v[32:47]
    buffer_load_dwordx4 v[108:111], v11, s[20:23], s35 offen offset:0
    v_mfma_f32_32x32x16_bf16 v[48:63], v[244:247], v[160:163], v[48:63]
    s_add_u32 m0, s36, 73728
    s_nop 0
    buffer_load_dwordx4 v253, s[8:11], s34 offen lds
    v_mfma_f32_32x32x16_bf16 v[176:191], v[244:247], v[164:167], v[176:191]
    buffer_load_dwordx4 v254, s[8:11], s34 offen offset:1024 lds
    s_waitcnt vmcnt(14)
    v_mfma_f32_32x32x16_bf16 v[16:31], v[64:67], v[168:171], v[16:31]
    buffer_load_dwordx4 v[160:163], v5, s[20:23], s35 offen offset:1024
    v_mfma_f32_32x32x16_bf16 v[32:47], v[64:67], v[172:175], v[32:47]
    buffer_load_dwordx4 v[164:167], v11, s[20:23], s35 offen offset:1024
    v_mfma_f32_32x32x16_bf16 v[48:63], v[68:71], v[168:171], v[48:63]
    s_add_u32 s34, s34, 229376
    s_cmp_ge_u32 s34, s82
    s_cselect_b32 s34, s83, s34
    s_add_u32 m0, s36, 0
    s_nop 0
    buffer_load_dwordx4 v1, s[8:11], s34 offen lds
    v_mfma_f32_32x32x16_bf16 v[176:191], v[68:71], v[172:175], v[176:191]
    buffer_load_dwordx4 v252, s[8:11], s34 offen offset:1024 lds
    s_load_dwordx16 s[64:79], s[80:81], 64 glc
    s_waitcnt vmcnt(14)
    v_mfma_f32_32x32x16_bf16 v[16:31], v[72:75], v[112:115], v[16:31]
    s_add_u32 s35, s35, 16384
    s_cmp_ge_u32 s35, s84
    s_cselect_b32 s35, s40, s35
    buffer_load_dwordx4 v[168:171], v5, s[20:23], s35 offen offset:0
    v_mfma_f32_32x32x16_bf16 v[32:47], v[72:75], v[116:119], v[32:47]
    buffer_load_dwordx4 v[172:175], v11, s[20:23], s35 offen offset:0
    v_mfma_f32_32x32x16_bf16 v[48:63], v[76:79], v[112:115], v[48:63]
    s_add_u32 m0, s36, 8192
    s_nop 0
    buffer_load_dwordx4 v253, s[8:11], s34 offen lds
    v_mfma_f32_32x32x16_bf16 v[176:191], v[76:79], v[116:119], v[176:191]
    buffer_load_dwordx4 v254, s[8:11], s34 offen offset:1024 lds
    s_waitcnt vmcnt(14)
    v_mfma_f32_32x32x16_bf16 v[16:31], v[128:131], v[120:123], v[16:31]
    buffer_load_dwordx4 v[112:115], v5, s[20:23], s35 offen offset:1024
    v_mfma_f32_32x32x16_bf16 v[32:47], v[128:131], v[124:127], v[32:47]
    buffer_load_dwordx4 v[116:119], v11, s[20:23], s35 offen offset:1024
    v_mfma_f32_32x32x16_bf16 v[48:63], v[132:135], v[120:123], v[48:63]
    s_add_u32 s34, s34, 229376
    s_cmp_ge_u32 s34, s82
    s_cselect_b32 s34, s83, s34
    s_add_u32 m0, s36, 16384
    s_nop 0
    buffer_load_dwordx4 v1, s[8:11], s34 offen lds
    v_mfma_f32_32x32x16_bf16 v[176:191], v[132:135], v[124:127], v[176:191]
    buffer_load_dwordx4 v252, s[8:11], s34 offen offset:1024 lds
    s_waitcnt vmcnt(14)
    s_mov_b32 s99, 65536
    s_branch FGB_pc
FGB_pl:
    s_load_dwordx16 s[64:79], s[80:81], 64 glc
FGB_pc:
    s_waitcnt lgkmcnt(0)
    s_sub_u32 s99, s99, 1
    s_cbranch_scc1 FGB_pd
    s_cmp_lg_u64 s[64:65], s[96:97]
    s_cbranch_scc1 FGB_pl
    s_cmp_lg_u64 s[66:67], s[96:97]
    s_cbranch_scc1 FGB_pl
    s_cmp_lg_u64 s[68:69], s[96:97]
    s_cbranch_scc1 FGB_pl
    s_cmp_lg_u64 s[70:71], s[96:97]
    s_cbranch_scc1 FGB_pl
    s_cmp_lg_u64 s[72:73], s[96:97]
    s_cbranch_scc1 FGB_pl
    s_cmp_lg_u64 s[74:75], s[96:97]
    s_cbranch_scc1 FGB_pl
    s_cmp_lg_u64 s[76:77], s[96:97]
    s_cbranch_scc1 FGB_pl
FGB_pd:
    v_mfma_f32_32x32x16_bf16 v[16:31], v[136:139], v[104:107], v[16:31]
    s_add_u32 s35, s35, 16384
    s_cmp_ge_u32 s35, s84
    s_cselect_b32 s35, s40, s35
    buffer_load_dwordx4 v[120:123], v5, s[20:23], s35 offen offset:2048
    v_mfma_f32_32x32x16_bf16 v[32:47], v[136:139], v[108:111], v[32:47]
    buffer_load_dwordx4 v[124:127], v11, s[20:23], s35 offen offset:2048
    v_mfma_f32_32x32x16_bf16 v[48:63], v[140:143], v[104:107], v[48:63]
    v_mfma_f32_32x32x16_bf16 v[176:191], v[140:143], v[108:111], v[176:191]
    s_waitcnt vmcnt(12)
    v_mfma_f32_32x32x16_bf16 v[16:31], v[80:83], v[160:163], v[16:31]
    buffer_load_dwordx4 v[104:107], v5, s[20:23], s35 offen offset:3072
    v_mfma_f32_32x32x16_bf16 v[32:47], v[80:83], v[164:167], v[32:47]
    buffer_load_dwordx4 v[108:111], v11, s[20:23], s35 offen offset:3072
    v_mfma_f32_32x32x16_bf16 v[48:63], v[84:87], v[160:163], v[48:63]
    v_mfma_f32_32x32x16_bf16 v[176:191], v[84:87], v[164:167], v[176:191]
    s_waitcnt vmcnt(10)
    v_mfma_f32_32x32x16_bf16 v[16:31], v[88:91], v[168:171], v[16:31]
    s_add_u32 s35, s35, 16384
    s_cmp_ge_u32 s35, s84
    s_cselect_b32 s35, s40, s35
    buffer_load_dwordx4 v[160:163], v5, s[20:23], s35 offen offset:2048
    v_mfma_f32_32x32x16_bf16 v[32:47], v[88:91], v[172:175], v[32:47]
    buffer_load_dwordx4 v[164:167], v11, s[20:23], s35 offen offset:2048
    v_mfma_f32_32x32x16_bf16 v[48:63], v[92:95], v[168:171], v[48:63]
    v_mfma_f32_32x32x16_bf16 v[176:191], v[92:95], v[172:175], v[176:191]
    s_waitcnt vmcnt(8)
    v_mfma_f32_32x32x16_bf16 v[16:31], v[144:147], v[112:115], v[16:31]
    buffer_load_dwordx4 v[168:171], v5, s[20:23], s35 offen offset:3072
    v_mfma_f32_32x32x16_bf16 v[32:47], v[144:147], v[116:119], v[32:47]
    buffer_load_dwordx4 v[172:175], v11, s[20:23], s35 offen offset:3072
    v_mfma_f32_32x32x16_bf16 v[48:63], v[148:151], v[112:115], v[48:63]
    v_mfma_f32_32x32x16_bf16 v[176:191], v[148:151], v[116:119], v[176:191]
    s_waitcnt vmcnt(6)
    v_mfma_f32_32x32x16_bf16 v[16:31], v[152:155], v[120:123], v[16:31]
    ds_read_b64_tr_b16 v[192:193], v13 offset:24576
    ds_read_b64_tr_b16 v[194:195], v13 offset:25600
    s_add_u32 s35, s35, 16384
    s_cmp_ge_u32 s35, s84
    s_cselect_b32 s35, s40, s35
    buffer_load_dwordx4 v[112:115], v5, s[20:23], s35 offen offset:2048
    v_mfma_f32_32x32x16_bf16 v[32:47], v[152:155], v[124:127], v[32:47]
    ds_read_b64_tr_b16 v[196:197], v14 offset:24576
    ds_read_b64_tr_b16 v[198:199], v14 offset:25600
    buffer_load_dwordx4 v[116:119], v11, s[20:23], s35 offen offset:2048
    v_mfma_f32_32x32x16_bf16 v[48:63], v[156:159], v[120:123], v[48:63]
    v_mfma_f32_32x32x16_bf16 v[176:191], v[156:159], v[124:127], v[176:191]
    s_waitcnt vmcnt(6)
    v_mfma_f32_32x32x16_bf16 v[16:31], v[96:99], v[104:107], v[16:31]
    ds_read_b64_tr_b16 v[200:201], v13 offset:49152
    ds_read_b64_tr_b16 v[202:203], v13 offset:50176
    buffer_load_dwordx4 v[120:123], v5, s[20:23], s35 offen offset:3072
    v_mfma_f32_32x32x16_bf16 v[32:47], v[96:99], v[108:111], v[32:47]
    ds_read_b64_tr_b16 v[204:205], v14 offset:49152
    ds_read_b64_tr_b16 v[206:207], v14 offset:50176
    buffer_load_dwordx4 v[124:127], v11, s[20:23], s35 offen offset:3072
    v_mfma_f32_32x32x16_bf16 v[48:63], v[100:103], v[104:107], v[48:63]
    v_mfma_f32_32x32x16_bf16 v[176:191], v[100:103], v[108:111], v[176:191]
    s_waitcnt vmcnt(6) lgkmcnt(4)
    v_mfma_f32_32x32x16_bf16 v[16:31], v[192:195], v[160:163], v[16:31]
    ds_read_b64_tr_b16 v[208:209], v13 offset:32768
    ds_read_b64_tr_b16 v[210:211], v13 offset:33792
    s_add_u32 s35, s35, 16384
    s_cmp_ge_u32 s35, s84
    s_cselect_b32 s35, s40, s35
    buffer_load_dwordx4 v[104:107], v5, s[20:23], s35 offen offset:2048
    v_mfma_f32_32x32x16_bf16 v[32:47], v[192:195], v[164:167], v[32:47]
    ds_read_b64_tr_b16 v[212:213], v14 offset:32768
    ds_read_b64_tr_b16 v[214:215], v14 offset:33792
    buffer_load_dwordx4 v[108:111], v11, s[20:23], s35 offen offset:2048
    v_mfma_f32_32x32x16_bf16 v[48:63], v[196:199], v[160:163], v[48:63]
    s_add_u32 m0, s36, 24576
    s_nop 0
    buffer_load_dwordx4 v253, s[8:11], s34 offen lds
    v_mfma_f32_32x32x16_bf16 v[176:191], v[196:199], v[164:167], v[176:191]
    buffer_load_dwordx4 v254, s[8:11], s34 offen offset:1024 lds
    s_waitcnt vmcnt(8) lgkmcnt(4)
    v_mfma_f32_32x32x16_bf16 v[16:31], v[200:203], v[168:171], v[16:31]
    ds_read_b64_tr_b16 v[216:217], v13 offset:40960
    ds_read_b64_tr_b16 v[218:219], v13 offset:41984
    buffer_load_dwordx4 v[160:163], v5, s[20:23], s35 offen offset:3072
    v_mfma_f32_32x32x16_bf16 v[32:47], v[200:203], v[172:175], v[32:47]
    ds_read_b64_tr_b16 v[220:221], v14 offset:40960
    ds_read_b64_tr_b16 v[222:223], v14 offset:41984
    buffer_load_dwordx4 v[164:167], v11, s[20:23], s35 offen offset:3072
    v_mfma_f32_32x32x16_bf16 v[48:63], v[204:207], v[168:171], v[48:63]
    s_add_u32 s34, s34, 229376
    s_cmp_ge_u32 s34, s82
    s_cselect_b32 s34, s83, s34
    s_add_u32 m0, s36, 49152
    s_nop 0
    buffer_load_dwordx4 v1, s[8:11], s34 offen lds
    v_mfma_f32_32x32x16_bf16 v[176:191], v[204:207], v[172:175], v[176:191]
    buffer_load_dwordx4 v252, s[8:11], s34 offen offset:1024 lds
    s_waitcnt vmcnt(10) lgkmcnt(4)
    v_mfma_f32_32x32x16_bf16 v[16:31], v[208:211], v[112:115], v[16:31]
    ds_read_b64_tr_b16 v[224:225], v3 offset:0
    ds_read_b64_tr_b16 v[226:227], v3 offset:1024
    s_add_u32 s35, s35, 16384
    s_cmp_ge_u32 s35, s84
    s_cselect_b32 s35, s40, s35
    buffer_load_dwordx4 v[168:171], v5, s[20:23], s35 offen offset:2048
    v_mfma_f32_32x32x16_bf16 v[32:47], v[208:211], v[116:119], v[32:47]
    ds_read_b64_tr_b16 v[228:229], v8 offset:0
    ds_read_b64_tr_b16 v[230:231], v8 offset:1024
    buffer_load_dwordx4 v[172:175], v11, s[20:23], s35 offen offset:2048
    v_mfma_f32_32x32x16_bf16 v[48:63], v[212:215], v[112:115], v[48:63]
    s_add_u32 m0, s36, 32768
    s_nop 0
    buffer_load_dwordx4 v253, s[8:11], s34 offen lds
    v_mfma_f32_32x32x16_bf16 v[176:191], v[212:215], v[116:119], v[176:191]
    buffer_load_dwordx4 v254, s[8:11], s34 offen offset:1024 lds
    s_waitcnt vmcnt(12) lgkmcnt(4)
    v_mfma_f32_32x32x16_bf16 v[16:31], v[216:219], v[120:123], v[16:31]
    ds_read_b64_tr_b16 v[232:233], v3 offset:8192
    ds_read_b64_tr_b16 v[234:235], v3 offset:9216
    buffer_load_dwordx4 v[112:115], v5, s[20:23], s35 offen offset:3072
    v_mfma_f32_32x32x16_bf16 v[32:47], v[216:219], v[124:127], v[32:47]
    ds_read_b64_tr_b16 v[236:237], v8 offset:8192
    ds_read_b64_tr_b16 v[238:239], v8 offset:9216
    buffer_load_dwordx4 v[116:119], v11, s[20:23], s35 offen offset:3072
    v_mfma_f32_32x32x16_bf16 v[48:63], v[220:223], v[120:123], v[48:63]
    v_mfma_f32_32x32x16_bf16 v[176:191], v[220:223], v[124:127], v[176:191]
    s_waitcnt vmcnt(12) lgkmcnt(4)
    v_mfma_f32_32x32x16_bf16 v[16:31], v[224:227], v[104:107], v[16:31]
    ds_read_b64_tr_b16 v[240:241], v13 offset:0
    ds_read_b64_tr_b16 v[242:243], v13 offset:1024
    s_add_u32 s35, s35, 16384
    s_cmp_ge_u32 s35, s84
    s_cselect_b32 s35, s40, s35
    buffer_load_dwordx4 v[120:123], v5, s[20:23], s35 offen offset:2048
    v_mfma_f32_32x32x16_bf16 v[32:47], v[224:227], v[108:111], v[32:47]
    ds_read_b64_tr_b16 v[244:245], v14 offset:0
    ds_read_b64_tr_b16 v[246:247], v14 offset:1024
    buffer_load_dwordx4 v[124:127], v11, s[20:23], s35 offen offset:2048
    v_mfma_f32_32x32x16_bf16 v[48:63], v[228:231], v[104:107], v[48:63]
    v_mfma_f32_32x32x16_bf16 v[176:191], v[228:231], v[108:111], v[176:191]
    s_waitcnt vmcnt(10) lgkmcnt(4)
    v_mfma_f32_32x32x16_bf16 v[16:31], v[232:235], v[160:163], v[16:31]
    ds_read_b64_tr_b16 v[64:65], v13 offset:8192
    ds_read_b64_tr_b16 v[66:67], v13 offset:9216
    buffer_load_dwordx4 v[104:107], v5, s[20:23], s35 offen offset:3072
    v_mfma_f32_32x32x16_bf16 v[32:47], v[232:235], v[164:167], v[32:47]
    ds_read_b64_tr_b16 v[68:69], v14 offset:8192
    ds_read_b64_tr_b16 v[70:71], v14 offset:9216
    buffer_load_dwordx4 v[108:111], v11, s[20:23], s35 offen offset:3072
    v_mfma_f32_32x32x16_bf16 v[48:63], v[236:239], v[160:163], v[48:63]
    v_mfma_f32_32x32x16_bf16 v[176:191], v[236:239], v[164:167], v[176:191]
    s_waitcnt vmcnt(8) lgkmcnt(4)
    v_mfma_f32_32x32x16_bf16 v[16:31], v[240:243], v[168:171], v[16:31]
    ds_read_b64_tr_b16 v[72:73], v13 offset:16384
    ds_read_b64_tr_b16 v[74:75], v13 offset:17408
    s_add_u32 s35, s35, 16384
    s_cmp_ge_u32 s35, s84
    s_cselect_b32 s35, s40, s35
    buffer_load_dwordx4 v[160:163], v5, s[20:23], s35 offen offset:2048
    v_mfma_f32_32x32x16_bf16 v[32:47], v[240:243], v[172:175], v[32:47]
    ds_read_b64_tr_b16 v[76:77], v14 offset:16384
    ds_read_b64_tr_b16 v[78:79], v14 offset:17408
    buffer_load_dwordx4 v[164:167], v11, s[20:23], s35 offen offset:2048
    v_mfma_f32_32x32x16_bf16 v[48:63], v[244:247], v[168:171], v[48:63]
    v_mfma_f32_32x32x16_bf16 v[176:191], v[244:247], v[172:175], v[176:191]
    s_waitcnt vmcnt(6) lgkmcnt(4)
    v_mfma_f32_32x32x16_bf16 v[16:31], v[64:67], v[112:115], v[16:31]
    ds_read_b64_tr_b16 v[128:129], v13 offset:24576
    ds_read_b64_tr_b16 v[130:131], v13 offset:25600
    buffer_load_dwordx4 v[168:171], v5, s[20:23], s35 offen offset:3072
    v_mfma_f32_32x32x16_bf16 v[32:47], v[64:67], v[116:119], v[32:47]
    ds_read_b64_tr_b16 v[132:133], v14 offset:24576
    ds_read_b64_tr_b16 v[134:135], v14 offset:25600
    buffer_load_dwordx4 v[172:175], v11, s[20:23], s35 offen offset:3072
    v_mfma_f32_32x32x16_bf16 v[48:63], v[68:71], v[112:115], v[48:63]
    v_mfma_f32_32x32x16_bf16 v[176:191], v[68:71], v[116:119], v[176:191]
    buffer_load_dwordx4 v[248:251], v7, s[56:59], 0 offen sc1
    s_waitcnt vmcnt(7) lgkmcnt(4)
    v_mfma_f32_32x32x16_bf16 v[16:31], v[72:75], v[120:123], v[16:31]
    ds_read_b64_tr_b16 v[136:137], v13 offset:49152
    ds_read_b64_tr_b16 v[138:139], v13 offset:50176
    v_mfma_f32_32x32x16_bf16 v[32:47], v[72:75], v[124:127], v[32:47]
    ds_read_b64_tr_b16 v[140:141], v14 offset:49152
    ds_read_b64_tr_b16 v[142:143], v14 offset:50176
    v_mfma_f32_32x32x16_bf16 v[48:63], v[76:79], v[120:123], v[48:63]
    v_mfma_f32_32x32x16_bf16 v[176:191], v[76:79], v[124:127], v[176:191]
    s_waitcnt vmcnt(5) lgkmcnt(4)
    v_mfma_f32_32x32x16_bf16 v[16:31], v[128:131], v[104:107], v[16:31]
    ds_read_b64_tr_b16 v[80:81], v13 offset:32768
    ds_read_b64_tr_b16 v[82:83], v13 offset:33792
    v_mfma_f32_32x32x16_bf16 v[32:47], v[128:131], v[108:111], v[32:47]
    ds_read_b64_tr_b16 v[84:85], v14 offset:32768
    ds_read_b64_tr_b16 v[86:87], v14 offset:33792
    v_mfma_f32_32x32x16_bf16 v[48:63], v[132:135], v[104:107], v[48:63]
    v_mfma_f32_32x32x16_bf16 v[176:191], v[132:135], v[108:111], v[176:191]
    s_waitcnt vmcnt(3) lgkmcnt(4)
    s_waitcnt vmcnt(1) lgkmcnt(0)
    s_waitcnt vmcnt(0)
    v_cmp_ne_u64 vcc, s[96:97], v[248:249]
    v_cmp_ne_u64 s[100:101], s[96:97], v[250:251]
    s_nop 1
    s_or_b64 vcc, vcc, s[100:101]
    s_cselect_b32 s98, 1, 0
    s_cmp_lg_u32 s98, 0
    s_cbranch_scc1 FG_atlater
    s_lshl_b32 s33, s43, 3
    s_add_u32 s33, s33, s24
    s_lshl_b32 s33, s33, 15
    s_lshl_b32 s38, s50, 7
    s_add_u32 s33, s33, s38
    s_lshl_b32 s39, s24, 10
    s_add_u32 m0, s39, 57344
    s_add_u32 s38, s33, 131072
    buffer_load_dwordx4 v2, s[12:15], s33 offen lds
    s_add_u32 m0, s39, 61440
    s_nop 0
    buffer_load_dwordx4 v2, s[12:15], s38 offen lds
FG_atlater:
    v_add_u32 v13, s36, v12
    v_mfma_f32_32x32x16_bf16 v[176:191], v[140:143], v[164:167], v[176:191]
    v_mfma_f32_32x32x16_bf16 v[176:191], v[84:87], v[172:175], v[176:191]
    v_mfma_f32_32x32x16_bf16 v[48:63], v[140:143], v[160:163], v[48:63]
    v_mfma_f32_32x32x16_bf16 v[48:63], v[84:87], v[168:171], v[48:63]
    v_mfma_f32_32x32x16_bf16 v[32:47], v[136:139], v[164:167], v[32:47]
    v_mfma_f32_32x32x16_bf16 v[32:47], v[80:83], v[172:175], v[32:47]
    s_nop 7
    ds_write_b128 v13, v[176:179] offset:32768
    ds_write_b128 v13, v[180:183] offset:33792
    ds_write_b128 v13, v[184:187] offset:40960
    ds_write_b128 v13, v[188:191] offset:41984
    v_mfma_f32_32x32x16_bf16 v[16:31], v[136:139], v[160:163], v[16:31]
    v_mfma_f32_32x32x16_bf16 v[16:31], v[80:83], v[168:171], v[16:31]
    s_nop 3
    ds_write_b128 v13, v[48:51] offset:16384
    ds_write_b128 v13, v[52:55] offset:17408
    ds_write_b128 v13, v[56:59] offset:24576
    ds_write_b128 v13, v[60:63] offset:25600
    v_add_u32 v13, s36, v12
    v_mov_b32 v11, 896
    v_lshrrev_b32 v5, 5, v0
    v_lshlrev_b32 v5, 4, v5
    v_mad_u32_u24 v11, v4, v11, v5
    v_xor_b32 v14, 2048, v13
    v_xor_b32 v15, 4096, v13
    v_xor_b32 v10, 6144, v13
    s_nop 3
    ds_write_b128 v13, v[32:35] offset:0
    ds_write_b128 v13, v[36:39] offset:1024
    ds_write_b128 v13, v[40:43] offset:8192
    ds_write_b128 v13, v[44:47] offset:9216
    s_cmp_eq_u32 s98, 0
    s_cbranch_scc1 FG_atdone
    s_mov_b32 s99, 65536
FGA_pl:
    buffer_load_dwordx4 v[248:251], v7, s[56:59], 0 offen sc1
    s_waitcnt vmcnt(0)
FGA_pc:
    v_cmp_ne_u64 vcc, s[96:97], v[248:249]
    v_cmp_ne_u64 s[100:101], s[96:97], v[250:251]
    s_sub_u32 s99, s99, 1
    s_cbranch_scc1 FGA_pd
    s_or_b64 vcc, vcc, s[100:101]
    s_cbranch_scc0 FGA_pd
    s_sleep 4
    s_branch FGA_pl
FGA_pd:
    s_lshl_b32 s33, s43, 3
    s_add_u32 s33, s33, s24
    s_lshl_b32 s33, s33, 15
    s_lshl_b32 s38, s50, 7
    s_add_u32 s33, s33, s38
    s_lshl_b32 s39, s24, 10
    s_add_u32 m0, s39, 57344
    s_add_u32 s38, s33, 131072
    buffer_load_dwordx4 v2, s[12:15], s33 offen lds
    s_add_u32 m0, s39, 61440
    s_nop 0
    buffer_load_dwordx4 v2, s[12:15], s38 offen lds
FG_atdone:
    s_lshl_b32 s33, s50, 1
    s_add_u32 s33, s33, s27
    s_mul_i32 s33, s33, 28672
    s_lshl_b32 s38, s43, 7
    s_add_u32 s33, s33, s38
    s_lshl_b32 s38, s32, 6
    s_add_u32 s33, s33, s38
    s_mov_b32 s39, 0xffff0000
    s_mov_b32 s20, s52
    s_mov_b32 s21, s53
    s_mov_b32 s22, 1835008
    s_mov_b32 s23, 0x00020000
    s_waitcnt vmcnt(0) lgkmcnt(0)
    s_barrier
    ds_read_b64_tr_b16 v[80:81], v9 offset:0
    ds_read_b64_tr_b16 v[82:83], v9 offset:1024
    ds_read_b64_tr_b16 v[84:85], v9 offset:2048
    ds_read_b64_tr_b16 v[86:87], v9 offset:3072
    ds_read_b128 v[96:99], v14 offset:0
    ds_read_b128 v[100:103], v14 offset:1024
    ds_read_b128 v[104:107], v14 offset:8192
    ds_read_b128 v[108:111], v14 offset:9216
    ds_read_b128 v[112:115], v15 offset:16384
    ds_read_b128 v[116:119], v15 offset:17408
    ds_read_b128 v[120:123], v15 offset:24576
    ds_read_b128 v[124:127], v15 offset:25600
    ds_read_b128 v[128:131], v10 offset:32768
    ds_read_b128 v[132:135], v10 offset:33792
    ds_read_b128 v[136:139], v10 offset:40960
    ds_read_b128 v[140:143], v10 offset:41984
    s_waitcnt lgkmcnt(12)
    v_lshlrev_b32 v144, 16, v80
    v_and_b32 v145, s39, v80
    v_lshlrev_b32 v146, 16, v81
    v_and_b32 v147, s39, v81
    v_lshlrev_b32 v148, 16, v82
    v_and_b32 v149, s39, v82
    v_lshlrev_b32 v150, 16, v83
    v_and_b32 v151, s39, v83
    v_lshlrev_b32 v152, 16, v84
    v_and_b32 v153, s39, v84
    v_lshlrev_b32 v154, 16, v85
    v_and_b32 v155, s39, v85
    v_lshlrev_b32 v156, 16, v86
    v_and_b32 v157, s39, v86
    v_lshlrev_b32 v158, 16, v87
    v_and_b32 v159, s39, v87
    v_mov_b32 v7, v6
    s_waitcnt lgkmcnt(8)
    v_pk_add_f32 v[16:17], v[16:17], v[96:97]
    v_pk_add_f32 v[18:19], v[18:19], v[98:99]
    v_pk_add_f32 v[20:21], v[20:21], v[100:101]
    v_pk_add_f32 v[22:23], v[22:23], v[102:103]
    v_pk_add_f32 v[24:25], v[24:25], v[104:105]
    v_pk_add_f32 v[26:27], v[26:27], v[106:107]
    v_pk_add_f32 v[28:29], v[28:29], v[108:109]
    v_pk_add_f32 v[30:31], v[30:31], v[110:111]
    s_waitcnt lgkmcnt(4)
    v_pk_add_f32 v[16:17], v[16:17], v[112:113]
    v_pk_add_f32 v[18:19], v[18:19], v[114:115]
    v_pk_add_f32 v[20:21], v[20:21], v[116:117]
    v_pk_add_f32 v[22:23], v[22:23], v[118:119]
    v_pk_add_f32 v[24:25], v[24:25], v[120:121]
    v_pk_add_f32 v[26:27], v[26:27], v[122:123]
    v_pk_add_f32 v[28:29], v[28:29], v[124:125]
    v_pk_add_f32 v[30:31], v[30:31], v[126:127]
    s_waitcnt lgkmcnt(0)
    v_pk_add_f32 v[16:17], v[16:17], v[128:129]
    v_pk_add_f32 v[18:19], v[18:19], v[130:131]
    v_pk_add_f32 v[20:21], v[20:21], v[132:133]
    v_pk_add_f32 v[22:23], v[22:23], v[134:135]
    v_pk_add_f32 v[24:25], v[24:25], v[136:137]
    v_pk_add_f32 v[26:27], v[26:27], v[138:139]
    v_pk_add_f32 v[28:29], v[28:29], v[140:141]
    v_pk_add_f32 v[30:31], v[30:31], v[142:143]
    v_pk_add_f32 v[144:145], v[144:145], v[16:17] neg_lo:[0,1] neg_hi:[0,1]
    v_pk_add_f32 v[146:147], v[146:147], v[18:19] neg_lo:[0,1] neg_hi:[0,1]
    v_pk_add_f32 v[148:149], v[148:149], v[20:21] neg_lo:[0,1] neg_hi:[0,1]
    v_pk_add_f32 v[150:151], v[150:151], v[22:23] neg_lo:[0,1] neg_hi:[0,1]
    v_pk_add_f32 v[152:153], v[152:153], v[24:25] neg_lo:[0,1] neg_hi:[0,1]
    v_pk_add_f32 v[154:155], v[154:155], v[26:27] neg_lo:[0,1] neg_hi:[0,1]
    v_pk_add_f32 v[156:157], v[156:157], v[28:29] neg_lo:[0,1] neg_hi:[0,1]
    v_pk_add_f32 v[158:159], v[158:159], v[30:31] neg_lo:[0,1] neg_hi:[0,1]
    v_pk_fma_f32 v[16:17], v[6:7], v[144:145], v[16:17]
    v_pk_fma_f32 v[18:19], v[6:7], v[146:147], v[18:19]
    v_pk_fma_f32 v[20:21], v[6:7], v[148:149], v[20:21]
    v_pk_fma_f32 v[22:23], v[6:7], v[150:151], v[22:23]
    v_pk_fma_f32 v[24:25], v[6:7], v[152:153], v[24:25]
    v_pk_fma_f32 v[26:27], v[6:7], v[154:155], v[26:27]
    v_pk_fma_f32 v[28:29], v[6:7], v[156:157], v[28:29]
    v_pk_fma_f32 v[30:31], v[6:7], v[158:159], v[30:31]
    v_cvt_pk_bf16_f32 v160, v16, v17
    v_cvt_pk_bf16_f32 v161, v18, v19
    v_cvt_pk_bf16_f32 v162, v20, v21
    v_cvt_pk_bf16_f32 v163, v22, v23
    v_cvt_pk_bf16_f32 v164, v24, v25
    v_cvt_pk_bf16_f32 v165, v26, v27
    v_cvt_pk_bf16_f32 v166, v28, v29
    v_cvt_pk_bf16_f32 v167, v30, v31
    s_nop 1
    v_permlane32_swap_b32 v160, v162
    v_permlane32_swap_b32 v161, v163
    v_permlane32_swap_b32 v164, v166
    v_permlane32_swap_b32 v165, v167
    buffer_store_dwordx4 v[160:163], v11, s[20:23], s33 offen offset:0
    buffer_store_dwordx4 v[164:167], v11, s[20:23], s33 offen offset:32
    s_endpgm
K_s:
    s_sub_u32 s33, s33, 28
    s_mov_b32 s87, s33
    s_mul_i32 s25, s3, 28
    s_add_u32 s25, s25, s33
    s_lshl_b32 s26, s3, 2
    s_and_b32 s27, s33, 3
    s_add_u32 s26, s26, s27
    s_lshr_b32 s27, s33, 2
    s_load_dwordx8 s[40:47], s[0:1], 8
    s_load_dwordx8 s[48:55], s[0:1], 40
    s_load_dwordx2 s[4:5], s[0:1], 0
    s_load_dwordx4 s[16:19], s[0:1], 96
    s_load_dwordx4 s[56:59], s[0:1], 120
    s_setprio 3
    v_lshrrev_b32 v13, 6, v0
    v_lshlrev_b32 v1, 2, v0
    v_readfirstlane_b32 s24, v13
    s_lshl_b32 s33, s25, 10
    s_lshl_b32 s34, s25, 2
    v_and_b32 v12, 63, v0
    v_lshrrev_b32 v14, 3, v12
    v_bfe_u32 v15, v12, 4, 1
    v_lshlrev_b32 v15, 1, v15
    v_and_b32 v3, 7, v12
    v_xor_b32 v3, v3, v15
    v_lshlrev_b32 v3, 4, v3
    v_mov_b32 v15, 896
    v_mad_u32_u24 v3, v14, v15, v3
    v_xor_b32 v4, 64, v3
    s_lshl_b32 s38, s26, 2
    s_add_u32 s38, s38, s24
    s_mul_i32 s38, s38, 14336
    s_lshl_b32 s39, s27, 7
    s_add_u32 s31, s38, s39
    s_lshr_b32 s35, s24, 1
    s_mul_i32 s35, s35, 4608
    s_and_b32 s38, s24, 1
    s_lshl_b32 s38, s38, 11
    s_add_u32 s35, s35, s38
    s_add_u32 s35, s35, 63296
    v_and_b32 v7, 3, v12
    v_lshlrev_b32 v6, 5, v7
    v_mov_b32 v29, 0
    s_mov_b32 s10, 229376
    s_mov_b32 s11, 0x00020000
    s_mov_b32 s14, 896
    s_mov_b32 s15, 0x00020000
    s_waitcnt lgkmcnt(0)
    s_mov_b32 s12, s52
    s_mov_b32 s13, s53
    buffer_load_dword v26, v29, s[12:15], s34 offen
    s_mov_b32 s8, s40
    s_mov_b32 s9, s41
    buffer_load_dword v38, v1, s[8:11], s33 offen
    s_mov_b32 s8, s42
    s_mov_b32 s9, s43
    buffer_load_dword v39, v1, s[8:11], s33 offen
    s_mov_b32 s8, s44
    s_mov_b32 s9, s45
    buffer_load_dword v40, v1, s[8:11], s33 offen
    s_mov_b32 s8, s46
    s_mov_b32 s9, s47
    buffer_load_dword v41, v1, s[8:11], s33 offen
    s_mov_b32 s8, s48
    s_mov_b32 s9, s49
    buffer_load_dword v42, v1, s[8:11], s33 offen
    s_mov_b32 s8, s50
    s_mov_b32 s9, s51
    buffer_load_dword v43, v1, s[8:11], s33 offen
    s_setprio 1
    s_mov_b32 s8, s4
    s_mov_b32 s9, s5
    s_mov_b32 s10, 1835008
    s_mov_b32 s11, 0x00020000
    s_mov_b32 s60, s56
    s_mov_b32 s61, s57
    s_mov_b32 s62, 256
    s_mov_b32 s63, 0x00020000
    s_mov_b32 s52, s54
    s_mov_b32 s53, s55
    s_mov_b32 s54, s18
    s_mov_b32 s55, s19
    s_mov_b32 s42, 896
    s_mov_b32 s43, 0x00020000
    s_mov_b32 s45, s31
    s_mov_b32 s46, s39
    v_mov_b32 v25, v6
    s_setprio 1
    s_mov_b32 s6, s58
    s_mov_b32 s7, s59
    s_mov_b32 s48, s16
    s_mov_b32 s49, s17
    s_mov_b32 s50, 1605632
    s_mov_b32 s51, 0x00020000
    s_add_u32 s12, s6, 8388608
    s_addc_u32 s13, s7, 0
    s_mov_b32 s14, 1835008
    s_mov_b32 s15, 0x00020000
    s_add_u32 s16, s6, 10485760
    s_addc_u32 s17, s7, 0
    s_mov_b32 s18, 1835008
    s_mov_b32 s19, 0x00020000
    s_add_u32 s20, s6, 12582912
    s_addc_u32 s21, s7, 0
    s_mov_b32 s22, 65536
    s_mov_b32 s23, 0x00020000
    s_add_u32 s56, s6, 13107200
    s_addc_u32 s57, s7, 0
    s_mov_b32 s58, 30720
    s_mov_b32 s59, 0x00020000
    s_lshl_b32 s85, s87, 2
    s_add_u32 s85, s85, s24
    s_lshl_b32 s85, s85, 13
    v_lshlrev_b32 v2, 7, v12
    v_mov_b32 v6, 49728
    ds_write_b32 v6, v29
    ds_write_b32 v6, v29 offset:3280
    ds_write_b32 v6, v29 offset:6560
    ds_write_b32 v6, v29 offset:9840
    v_and_b32 v6, 127, v0
    v_lshlrev_b32 v6, 2, v6
    v_lshrrev_b32 v5, 7, v0
    v_mov_b32 v14, 4608
    v_mad_u32_u24 v6, v5, v14, v6
    v_add_u32 v6, 62784, v6
    ds_write_b32 v6, v29
    v_and_b32 v6, 15, v12
    v_lshrrev_b32 v5, 4, v12
    v_mul_u32_u24 v8, 320, v5
    v_lshl_add_u32 v8, v6, 2, v8
    s_mul_i32 s39, s24, 3280
    s_add_u32 s39, s39, 49664
    v_add_u32 v28, s39, v8
    v_bfe_u32 v6, v12, 2, 2
    v_and_b32 v8, 1, v5
    v_lshl_add_u32 v9, v8, 3, v6
    v_lshlrev_b32 v9, 7, v9
    v_lshl_add_u32 v9, v7, 3, v9
    v_add_u32 v9, s35, v9
    v_lshrrev_b32 v10, 1, v6
    v_lshl_or_b32 v10, v8, 1, v10
    v_lshrrev_b32 v11, 1, v5
    v_xor_b32 v10, v10, v11
    v_lshl_add_u32 v13, v10, 5, v9
    v_xor_b32 v10, 2, v10
    v_lshl_add_u32 v14, v10, 5, v9
    v_lshl_add_u32 v10, v11, 2, v6
    v_lshlrev_b32 v10, 14, v10
    v_lshl_add_u32 v10, v8, 6, v10
    v_lshl_add_u32 v15, v7, 4, v10
    v_lshrrev_b32 v5, 2, v12
    v_bfe_u32 v6, v5, 1, 1
    v_bfe_u32 v8, v5, 3, 1
    v_lshl_or_b32 v6, v8, 1, v6
    v_xor_b32 v6, v6, v7
    v_lshlrev_b32 v6, 5, v6
    v_lshl_add_u32 v6, v5, 7, v6
    v_add_u32 v6, s35, v6
    v_lshlrev_b32 v5, 5, v5
    s_lshl_b32 s38, s27, 18
    s_lshl_b32 s39, s26, 2
    s_add_u32 s39, s39, s24
    s_lshl_b32 s32, s39, 7
    s_add_u32 s30, s38, s32
    s_lshl_b32 s39, s39, 9
    s_lshl_b32 s32, s27, 2
    s_add_u32 s31, s39, s32
    s_add_u32 s32, s30, 131072
    s_waitcnt vmcnt(0)
    v_lshlrev_b32 v44, 16, v26
    v_and_b32 v26, 0xffff0000, v26
    s_cmp_ge_u32 s24, 2
    s_cselect_b64 vcc, -1, 0
    v_cndmask_b32 v44, v44, v26, vcc
    v_mul_f32 v44, 0x3fb8aa3b, v44
    v_exp_f32 v44, v44
    s_nop 0
    v_cvt_pk_bf16_f32 v44, v44, v44
    v_lshlrev_b32 v44, 16, v44
    s_mov_b32 vcc_lo, 0xff00ff
    s_mov_b32 vcc_hi, 0xff00ff
    v_lshlrev_b32 v32, 16, v38
    v_lshlrev_b32 v33, 16, v39
    v_lshlrev_b32 v34, 16, v40
    v_lshlrev_b32 v35, 16, v41
    v_lshlrev_b32 v36, 16, v42
    v_lshlrev_b32 v37, 16, v43
    v_mul_f32 v32, v44, v32
    v_mul_f32 v33, v44, v33
    v_mul_f32 v34, v44, v34
    v_mul_f32 v35, v44, v35
    v_mul_f32 v45, 0x3fb8aa3b, v32
    v_mul_f32 v46, 0x3e22f983, v33
    v_mul_f32 v68, v36, v34
    v_mul_f32 v69, v36, v35
    v_fma_f32 v68, -v37, v35, v68
    v_fmac_f32 v69, v37, v34
    v_mul_f32 v60, 0x41000000, v45
    v_mul_f32 v70, 0x41000000, v46
    v_exp_f32 v60, v60
    v_rndne_f32 v61, v70
    v_sub_f32 v61, v70, v61
    v_cos_f32 v70, v61
    v_sin_f32 v71, v61
    v_mul_f32 v70, v70, v60
    v_mul_f32 v71, v71, v60
    v_sub_f32 v47, 0, v71
    v_exp_f32 v62, v45
    v_rndne_f32 v63, v46
    v_sub_f32 v63, v46, v63
    v_cos_f32 v72, v63
    v_sin_f32 v73, v63
    v_mul_f32 v72, v72, v62
    v_mul_f32 v73, v73, v62
    v_sub_f32 v58, 0, v73
    v_mul_f32 v64, 0x43000000, v45
    v_mul_f32 v74, 0x43000000, v46
    v_exp_f32 v64, v64
    v_rndne_f32 v65, v74
    v_sub_f32 v65, v74, v65
    v_cos_f32 v74, v65
    v_sin_f32 v75, v65
    v_mul_f32 v74, v74, v64
    v_mul_f32 v75, v75, v64
    v_sub_f32 v59, 0, v75
    v_cvt_pk_bf16_f32 v152, v68, -v69
    v_mul_f32 v56, v68, v70
    v_mul_f32 v57, v68, v71
    v_fmac_f32 v56, v69, v47
    v_fmac_f32 v57, v69, v70
    v_cvt_pk_bf16_f32 v153, v56, -v57
    v_mul_f32 v68, v56, v70
    v_mul_f32 v69, v56, v71
    v_fmac_f32 v68, v57, v47
    v_fmac_f32 v69, v57, v70
    v_cvt_pk_bf16_f32 v154, v68, -v69
    v_mul_f32 v56, v68, v70
    v_mul_f32 v57, v68, v71
    v_fmac_f32 v56, v69, v47
    v_fmac_f32 v57, v69, v70
    v_cvt_pk_bf16_f32 v155, v56, -v57
    v_mul_f32 v68, v56, v70
    v_mul_f32 v69, v56, v71
    v_fmac_f32 v68, v57, v47
    v_fmac_f32 v69, v57, v70
    v_cvt_pk_bf16_f32 v156, v68, -v69
    v_mul_f32 v56, v68, v70
    v_mul_f32 v57, v68, v71
    v_fmac_f32 v56, v69, v47
    v_fmac_f32 v57, v69, v70
    v_cvt_pk_bf16_f32 v157, v56, -v57
    v_mul_f32 v68, v56, v70
    v_mul_f32 v69, v56, v71
    v_fmac_f32 v68, v57, v47
    v_fmac_f32 v69, v57, v70
    v_cvt_pk_bf16_f32 v158, v68, -v69
    v_mul_f32 v56, v68, v70
    v_mul_f32 v57, v68, v71
    v_fmac_f32 v56, v69, v47
    v_fmac_f32 v57, v69, v70
    v_cvt_pk_bf16_f32 v159, v56, -v57
    v_mul_f32 v68, v56, v70
    v_mul_f32 v69, v56, v71
    v_fmac_f32 v68, v57, v47
    v_fmac_f32 v69, v57, v70
    v_cvt_pk_bf16_f32 v160, v68, -v69
    v_mul_f32 v56, v68, v70
    v_mul_f32 v57, v68, v71
    v_cndmask_b32_dpp v184, v160, v152, vcc row_ror:8 row_mask:0xf bank_mask:0xf
    v_fmac_f32 v56, v69, v47
    v_fmac_f32 v57, v69, v70
    v_cvt_pk_bf16_f32 v161, v56, -v57
    v_mul_f32 v68, v56, v70
    v_mul_f32 v69, v56, v71
    v_cndmask_b32_dpp v185, v161, v153, vcc row_ror:8 row_mask:0xf bank_mask:0xf
    v_fmac_f32 v68, v57, v47
    v_fmac_f32 v69, v57, v70
    v_cvt_pk_bf16_f32 v162, v68, -v69
    v_mul_f32 v56, v68, v70
    v_mul_f32 v57, v68, v71
    v_cndmask_b32_dpp v186, v162, v154, vcc row_ror:8 row_mask:0xf bank_mask:0xf
    v_fmac_f32 v56, v69, v47
    v_fmac_f32 v57, v69, v70
    v_cvt_pk_bf16_f32 v163, v56, -v57
    v_mul_f32 v68, v56, v70
    v_mul_f32 v69, v56, v71
    v_cndmask_b32_dpp v187, v163, v155, vcc row_ror:8 row_mask:0xf bank_mask:0xf
    v_fmac_f32 v68, v57, v47
    v_fmac_f32 v69, v57, v70
    v_cvt_pk_bf16_f32 v164, v68, -v69
    v_mul_f32 v56, v68, v70
    v_mul_f32 v57, v68, v71
    v_cndmask_b32_dpp v188, v164, v156, vcc row_ror:8 row_mask:0xf bank_mask:0xf
    v_fmac_f32 v56, v69, v47
    v_fmac_f32 v57, v69, v70
    v_cvt_pk_bf16_f32 v165, v56, -v57
    v_mul_f32 v68, v56, v70
    v_mul_f32 v69, v56, v71
    v_cndmask_b32_dpp v189, v165, v157, vcc row_ror:8 row_mask:0xf bank_mask:0xf
    v_fmac_f32 v68, v57, v47
    v_fmac_f32 v69, v57, v70
    v_cvt_pk_bf16_f32 v166, v68, -v69
    v_mul_f32 v56, v68, v70
    v_mul_f32 v57, v68, v71
    v_cndmask_b32_dpp v190, v166, v158, vcc row_ror:8 row_mask:0xf bank_mask:0xf
    v_fmac_f32 v56, v69, v47
    v_fmac_f32 v57, v69, v70
    v_cvt_pk_bf16_f32 v167, v56, -v57
    v_mul_f32 v76, v72, v72
    v_mul_f32 v77, v72, v73
    v_cndmask_b32_dpp v191, v167, v159, vcc row_ror:8 row_mask:0xf bank_mask:0xf
    s_not_b64 vcc, vcc
    v_fmac_f32 v76, v73, v58
    v_cndmask_b32_dpp v192, v152, v160, vcc row_ror:8 row_mask:0xf bank_mask:0xf
    v_fmac_f32 v77, v73, v72
    v_cndmask_b32_dpp v193, v153, v161, vcc row_ror:8 row_mask:0xf bank_mask:0xf
    v_mul_f32 v78, v76, v72
    v_cndmask_b32_dpp v194, v154, v162, vcc row_ror:8 row_mask:0xf bank_mask:0xf
    v_mul_f32 v79, v76, v73
    v_cndmask_b32_dpp v195, v155, v163, vcc row_ror:8 row_mask:0xf bank_mask:0xf
    v_fmac_f32 v78, v77, v58
    v_cndmask_b32_dpp v196, v156, v164, vcc row_ror:8 row_mask:0xf bank_mask:0xf
    v_fmac_f32 v79, v77, v72
    v_cndmask_b32_dpp v197, v157, v165, vcc row_ror:8 row_mask:0xf bank_mask:0xf
    v_mul_f32 v80, v78, v72
    v_cndmask_b32_dpp v198, v158, v166, vcc row_ror:8 row_mask:0xf bank_mask:0xf
    v_mul_f32 v81, v78, v73
    v_cndmask_b32_dpp v199, v159, v167, vcc row_ror:8 row_mask:0xf bank_mask:0xf
    s_mov_b32 vcc_lo, 0xf0f0f0f
    s_mov_b32 vcc_hi, 0xf0f0f0f
    v_fmac_f32 v80, v79, v58
    v_cndmask_b32_dpp v152, v188, v184, vcc row_ror:4 row_mask:0xf bank_mask:0xf
    v_fmac_f32 v81, v79, v72
    v_cndmask_b32_dpp v153, v189, v185, vcc row_ror:4 row_mask:0xf bank_mask:0xf
    v_mul_f32 v82, v80, v72
    v_cndmask_b32_dpp v154, v190, v186, vcc row_ror:4 row_mask:0xf bank_mask:0xf
    v_mul_f32 v83, v80, v73
    v_cndmask_b32_dpp v155, v191, v187, vcc row_ror:4 row_mask:0xf bank_mask:0xf
    v_fmac_f32 v82, v81, v58
    v_cndmask_b32_dpp v160, v196, v192, vcc row_ror:4 row_mask:0xf bank_mask:0xf
    v_fmac_f32 v83, v81, v72
    v_cndmask_b32_dpp v161, v197, v193, vcc row_ror:4 row_mask:0xf bank_mask:0xf
    v_mul_f32 v84, v82, v72
    v_cndmask_b32_dpp v162, v198, v194, vcc row_ror:4 row_mask:0xf bank_mask:0xf
    v_mul_f32 v85, v82, v73
    s_mov_b32 s40, s52
    s_mov_b32 s41, s53
    buffer_load_dword v27, v29, s[40:43], s34 offen
    s_mov_b32 m0, s35
    s_add_u32 s44, s45, 7168
    buffer_load_dwordx4 v3, s[8:11], s45 offen lds
    s_add_u32 m0, s35, 1024
    s_mov_b32 s40, s54
    buffer_load_dwordx4 v4, s[8:11], s44 offen lds
    s_mov_b32 s41, s55
    buffer_load_dwordx2 v[30:31], v29, s[60:63], 0 offen sc1
    buffer_load_dwordx4 v[48:51], v25, s[40:43], s46 offen
    buffer_load_dwordx4 v[52:55], v25, s[40:43], s46 offen offset:16
    v_cndmask_b32_dpp v163, v199, v195, vcc row_ror:4 row_mask:0xf bank_mask:0xf
    s_not_b64 vcc, vcc
    v_fmac_f32 v84, v83, v58
    v_cndmask_b32_dpp v156, v184, v188, vcc row_ror:12 row_mask:0xf bank_mask:0xf
    v_fmac_f32 v85, v83, v72
    v_cndmask_b32_dpp v157, v185, v189, vcc row_ror:12 row_mask:0xf bank_mask:0xf
    v_mul_f32 v86, v84, v72
    v_cndmask_b32_dpp v158, v186, v190, vcc row_ror:12 row_mask:0xf bank_mask:0xf
    v_mul_f32 v87, v84, v73
    v_cndmask_b32_dpp v159, v187, v191, vcc row_ror:12 row_mask:0xf bank_mask:0xf
    v_fmac_f32 v86, v85, v58
    v_cndmask_b32_dpp v164, v192, v196, vcc row_ror:12 row_mask:0xf bank_mask:0xf
    v_fmac_f32 v87, v85, v72
    v_cndmask_b32_dpp v165, v193, v197, vcc row_ror:12 row_mask:0xf bank_mask:0xf
    v_mul_f32 v88, v72, v74
    v_cndmask_b32_dpp v166, v194, v198, vcc row_ror:12 row_mask:0xf bank_mask:0xf
    v_mul_f32 v89, v72, v75
    v_cndmask_b32_dpp v167, v195, v199, vcc row_ror:12 row_mask:0xf bank_mask:0xf
    s_mov_b32 vcc_lo, 0x33333333
    s_mov_b32 vcc_hi, 0x33333333
    v_fmac_f32 v88, v73, v59
    v_cndmask_b32_dpp v184, v154, v152, vcc quad_perm:[2,3,0,1] row_mask:0xf bank_mask:0xf
    v_fmac_f32 v89, v73, v74
    v_cndmask_b32_dpp v185, v155, v153, vcc quad_perm:[2,3,0,1] row_mask:0xf bank_mask:0xf
    v_mul_f32 v90, v76, v74
    v_cndmask_b32_dpp v188, v158, v156, vcc quad_perm:[2,3,0,1] row_mask:0xf bank_mask:0xf
    v_mul_f32 v91, v76, v75
    v_cndmask_b32_dpp v189, v159, v157, vcc quad_perm:[2,3,0,1] row_mask:0xf bank_mask:0xf
    v_fmac_f32 v90, v77, v59
    v_cndmask_b32_dpp v192, v162, v160, vcc quad_perm:[2,3,0,1] row_mask:0xf bank_mask:0xf
    v_fmac_f32 v91, v77, v74
    v_cndmask_b32_dpp v193, v163, v161, vcc quad_perm:[2,3,0,1] row_mask:0xf bank_mask:0xf
    v_mul_f32 v92, v78, v74
    v_cndmask_b32_dpp v196, v166, v164, vcc quad_perm:[2,3,0,1] row_mask:0xf bank_mask:0xf
    v_mul_f32 v93, v78, v75
    v_cndmask_b32_dpp v197, v167, v165, vcc quad_perm:[2,3,0,1] row_mask:0xf bank_mask:0xf
    s_not_b64 vcc, vcc
    v_fmac_f32 v92, v79, v59
    v_cndmask_b32_dpp v186, v152, v154, vcc quad_perm:[2,3,0,1] row_mask:0xf bank_mask:0xf
    v_fmac_f32 v93, v79, v74
    v_cndmask_b32_dpp v187, v153, v155, vcc quad_perm:[2,3,0,1] row_mask:0xf bank_mask:0xf
    v_mul_f32 v94, v80, v74
    v_cndmask_b32_dpp v190, v156, v158, vcc quad_perm:[2,3,0,1] row_mask:0xf bank_mask:0xf
    v_mul_f32 v95, v80, v75
    v_cndmask_b32_dpp v191, v157, v159, vcc quad_perm:[2,3,0,1] row_mask:0xf bank_mask:0xf
    v_fmac_f32 v94, v81, v59
    v_cndmask_b32_dpp v194, v160, v162, vcc quad_perm:[2,3,0,1] row_mask:0xf bank_mask:0xf
    v_fmac_f32 v95, v81, v74
    v_cndmask_b32_dpp v195, v161, v163, vcc quad_perm:[2,3,0,1] row_mask:0xf bank_mask:0xf
    v_mul_f32 v96, v82, v74
    v_cndmask_b32_dpp v198, v164, v166, vcc quad_perm:[2,3,0,1] row_mask:0xf bank_mask:0xf
    v_mul_f32 v97, v82, v75
    v_cndmask_b32_dpp v199, v165, v167, vcc quad_perm:[2,3,0,1] row_mask:0xf bank_mask:0xf
    s_mov_b32 vcc_lo, 0x55555555
    s_mov_b32 vcc_hi, 0x55555555
    v_fmac_f32 v96, v83, v59
    v_cndmask_b32_dpp v216, v185, v184, vcc quad_perm:[1,0,3,2] row_mask:0xf bank_mask:0xf
    v_fmac_f32 v97, v83, v74
    v_cndmask_b32_dpp v218, v187, v186, vcc quad_perm:[1,0,3,2] row_mask:0xf bank_mask:0xf
    v_mul_f32 v98, v84, v74
    v_cndmask_b32_dpp v220, v189, v188, vcc quad_perm:[1,0,3,2] row_mask:0xf bank_mask:0xf
    v_mul_f32 v99, v84, v75
    v_cndmask_b32_dpp v222, v191, v190, vcc quad_perm:[1,0,3,2] row_mask:0xf bank_mask:0xf
    v_fmac_f32 v98, v85, v59
    v_cndmask_b32_dpp v224, v193, v192, vcc quad_perm:[1,0,3,2] row_mask:0xf bank_mask:0xf
    v_fmac_f32 v99, v85, v74
    v_cndmask_b32_dpp v226, v195, v194, vcc quad_perm:[1,0,3,2] row_mask:0xf bank_mask:0xf
    v_mul_f32 v100, v86, v74
    v_cndmask_b32_dpp v228, v197, v196, vcc quad_perm:[1,0,3,2] row_mask:0xf bank_mask:0xf
    v_mul_f32 v101, v86, v75
    v_cndmask_b32_dpp v230, v199, v198, vcc quad_perm:[1,0,3,2] row_mask:0xf bank_mask:0xf
    s_not_b64 vcc, vcc
    v_fmac_f32 v100, v87, v59
    v_cndmask_b32_dpp v217, v184, v185, vcc quad_perm:[1,0,3,2] row_mask:0xf bank_mask:0xf
    v_fmac_f32 v101, v87, v74
    v_cndmask_b32_dpp v219, v186, v187, vcc quad_perm:[1,0,3,2] row_mask:0xf bank_mask:0xf
    v_mov_b32 v168, 0x3f80
    v_cndmask_b32_dpp v221, v188, v189, vcc quad_perm:[1,0,3,2] row_mask:0xf bank_mask:0xf
    v_cvt_pk_bf16_f32 v169, v72, v73
    v_cndmask_b32_dpp v223, v190, v191, vcc quad_perm:[1,0,3,2] row_mask:0xf bank_mask:0xf
    v_cvt_pk_bf16_f32 v170, v76, v77
    v_cndmask_b32_dpp v225, v192, v193, vcc quad_perm:[1,0,3,2] row_mask:0xf bank_mask:0xf
    v_cvt_pk_bf16_f32 v171, v78, v79
    v_cndmask_b32_dpp v227, v194, v195, vcc quad_perm:[1,0,3,2] row_mask:0xf bank_mask:0xf
    v_cvt_pk_bf16_f32 v172, v80, v81
    v_cndmask_b32_dpp v229, v196, v197, vcc quad_perm:[1,0,3,2] row_mask:0xf bank_mask:0xf
    v_cvt_pk_bf16_f32 v173, v82, v83
    v_cndmask_b32_dpp v231, v198, v199, vcc quad_perm:[1,0,3,2] row_mask:0xf bank_mask:0xf
    s_mov_b32 vcc_lo, 0xff00ff
    s_mov_b32 vcc_hi, 0xff00ff
    v_cvt_pk_bf16_f32 v174, v84, v85
    v_cvt_pk_bf16_f32 v175, v86, v87
    v_cvt_pk_bf16_f32 v176, v74, v75
    v_cvt_pk_bf16_f32 v177, v88, v89
    v_cvt_pk_bf16_f32 v178, v90, v91
    v_cndmask_b32_dpp v184, v176, v168, vcc row_ror:8 row_mask:0xf bank_mask:0xf
    v_cvt_pk_bf16_f32 v179, v92, v93
    v_cndmask_b32_dpp v185, v177, v169, vcc row_ror:8 row_mask:0xf bank_mask:0xf
    v_cvt_pk_bf16_f32 v180, v94, v95
    v_cndmask_b32_dpp v186, v178, v170, vcc row_ror:8 row_mask:0xf bank_mask:0xf
    v_cvt_pk_bf16_f32 v181, v96, v97
    v_cndmask_b32_dpp v187, v179, v171, vcc row_ror:8 row_mask:0xf bank_mask:0xf
    v_cvt_pk_bf16_f32 v182, v98, v99
    v_cndmask_b32_dpp v188, v180, v172, vcc row_ror:8 row_mask:0xf bank_mask:0xf
    v_cvt_pk_bf16_f32 v183, v100, v101
    v_cndmask_b32_dpp v189, v181, v173, vcc row_ror:8 row_mask:0xf bank_mask:0xf
    v_mul_f32 v102, v74, v74
    v_cndmask_b32_dpp v190, v182, v174, vcc row_ror:8 row_mask:0xf bank_mask:0xf
    v_mul_f32 v103, v74, v75
    v_cndmask_b32_dpp v191, v183, v175, vcc row_ror:8 row_mask:0xf bank_mask:0xf
    s_not_b64 vcc, vcc
    v_fmac_f32 v102, v75, v59
    v_cndmask_b32_dpp v192, v168, v176, vcc row_ror:8 row_mask:0xf bank_mask:0xf
    v_fmac_f32 v103, v75, v74
    v_cndmask_b32_dpp v193, v169, v177, vcc row_ror:8 row_mask:0xf bank_mask:0xf
    v_cvt_pk_bf16_f32 v152, v102, v103
    v_cndmask_b32_dpp v194, v170, v178, vcc row_ror:8 row_mask:0xf bank_mask:0xf
    v_mul_f32 v104, v88, v88
    v_cndmask_b32_dpp v195, v171, v179, vcc row_ror:8 row_mask:0xf bank_mask:0xf
    v_add_f32 v63, v88, v88
    v_cndmask_b32_dpp v196, v172, v180, vcc row_ror:8 row_mask:0xf bank_mask:0xf
    v_fma_f32 v104, -v89, v89, v104
    v_cndmask_b32_dpp v197, v173, v181, vcc row_ror:8 row_mask:0xf bank_mask:0xf
    v_mul_f32 v105, v63, v89
    v_cndmask_b32_dpp v198, v174, v182, vcc row_ror:8 row_mask:0xf bank_mask:0xf
    v_cvt_pk_bf16_f32 v153, v104, v105
    v_cndmask_b32_dpp v199, v175, v183, vcc row_ror:8 row_mask:0xf bank_mask:0xf
    s_mov_b32 vcc_lo, 0xf0f0f0f
    s_mov_b32 vcc_hi, 0xf0f0f0f
    v_mul_f32 v106, v90, v90
    v_cndmask_b32_dpp v168, v188, v184, vcc row_ror:4 row_mask:0xf bank_mask:0xf
    v_add_f32 v60, v90, v90
    v_cndmask_b32_dpp v169, v189, v185, vcc row_ror:4 row_mask:0xf bank_mask:0xf
    v_fma_f32 v106, -v91, v91, v106
    v_cndmask_b32_dpp v170, v190, v186, vcc row_ror:4 row_mask:0xf bank_mask:0xf
    v_mul_f32 v107, v60, v91
    v_cndmask_b32_dpp v171, v191, v187, vcc row_ror:4 row_mask:0xf bank_mask:0xf
    v_cvt_pk_bf16_f32 v154, v106, v107
    v_cndmask_b32_dpp v176, v196, v192, vcc row_ror:4 row_mask:0xf bank_mask:0xf
    v_mul_f32 v108, v92, v92
    v_cndmask_b32_dpp v177, v197, v193, vcc row_ror:4 row_mask:0xf bank_mask:0xf
    v_add_f32 v61, v92, v92
    v_cndmask_b32_dpp v178, v198, v194, vcc row_ror:4 row_mask:0xf bank_mask:0xf
    v_fma_f32 v108, -v93, v93, v108
    v_cndmask_b32_dpp v179, v199, v195, vcc row_ror:4 row_mask:0xf bank_mask:0xf
    s_not_b64 vcc, vcc
    v_mul_f32 v109, v61, v93
    v_cndmask_b32_dpp v172, v184, v188, vcc row_ror:12 row_mask:0xf bank_mask:0xf
    v_cvt_pk_bf16_f32 v155, v108, v109
    v_cndmask_b32_dpp v173, v185, v189, vcc row_ror:12 row_mask:0xf bank_mask:0xf
    v_mul_f32 v110, v102, v74
    v_cndmask_b32_dpp v174, v186, v190, vcc row_ror:12 row_mask:0xf bank_mask:0xf
    v_mul_f32 v111, v102, v75
    v_cndmask_b32_dpp v175, v187, v191, vcc row_ror:12 row_mask:0xf bank_mask:0xf
    v_fmac_f32 v110, v103, v59
    v_cndmask_b32_dpp v180, v192, v196, vcc row_ror:12 row_mask:0xf bank_mask:0xf
    v_fmac_f32 v111, v103, v74
    v_cndmask_b32_dpp v181, v193, v197, vcc row_ror:12 row_mask:0xf bank_mask:0xf
    v_cvt_pk_bf16_f32 v156, v110, v111
    v_cndmask_b32_dpp v182, v194, v198, vcc row_ror:12 row_mask:0xf bank_mask:0xf
    v_mul_f32 v112, v104, v74
    v_cndmask_b32_dpp v183, v195, v199, vcc row_ror:12 row_mask:0xf bank_mask:0xf
    s_mov_b32 vcc_lo, 0x33333333
    s_mov_b32 vcc_hi, 0x33333333
    v_mul_f32 v113, v104, v75
    v_cndmask_b32_dpp v184, v170, v168, vcc quad_perm:[2,3,0,1] row_mask:0xf bank_mask:0xf
    v_fmac_f32 v112, v105, v59
    v_cndmask_b32_dpp v185, v171, v169, vcc quad_perm:[2,3,0,1] row_mask:0xf bank_mask:0xf
    v_fmac_f32 v113, v105, v74
    v_cndmask_b32_dpp v188, v174, v172, vcc quad_perm:[2,3,0,1] row_mask:0xf bank_mask:0xf
    v_cvt_pk_bf16_f32 v157, v112, v113
    v_cndmask_b32_dpp v189, v175, v173, vcc quad_perm:[2,3,0,1] row_mask:0xf bank_mask:0xf
    v_mul_f32 v114, v106, v74
    v_cndmask_b32_dpp v192, v178, v176, vcc quad_perm:[2,3,0,1] row_mask:0xf bank_mask:0xf
    v_mul_f32 v115, v106, v75
    v_cndmask_b32_dpp v193, v179, v177, vcc quad_perm:[2,3,0,1] row_mask:0xf bank_mask:0xf
    v_fmac_f32 v114, v107, v59
    v_cndmask_b32_dpp v196, v182, v180, vcc quad_perm:[2,3,0,1] row_mask:0xf bank_mask:0xf
    v_fmac_f32 v115, v107, v74
    v_cndmask_b32_dpp v197, v183, v181, vcc quad_perm:[2,3,0,1] row_mask:0xf bank_mask:0xf
    s_not_b64 vcc, vcc
    s_waitcnt vmcnt(0)
    ds_read_b64_tr_b16 v[244:245], v13
    ds_read_b64_tr_b16 v[246:247], v13 offset:512
    ds_read_b64_tr_b16 v[248:249], v14
    ds_read_b64_tr_b16 v[250:251], v14 offset:512
    ds_read_b128 v[16:19], v6
    ds_read_b128 v[20:23], v6 offset:16
    v_readfirstlane_b32 s96, v30
    v_readfirstlane_b32 s97, v31
    v_readfirstlane_b32 s37, v27
    v_mov_b32 v8, 0
    s_waitcnt lgkmcnt(2)
    buffer_store_dwordx4 v[244:247], v15, s[12:15], s30 offen sc1
    buffer_store_dwordx4 v[248:251], v15, s[12:15], s32 offen sc1
    s_waitcnt lgkmcnt(0)
    v_dot2_f32_bf16 v8, v16, v48, v8
    v_dot2_f32_bf16 v8, v17, v49, v8
    v_dot2_f32_bf16 v8, v18, v50, v8
    v_dot2_f32_bf16 v8, v19, v51, v8
    v_dot2_f32_bf16 v8, v20, v52, v8
    v_dot2_f32_bf16 v8, v21, v53, v8
    v_dot2_f32_bf16 v8, v22, v54, v8
    v_dot2_f32_bf16 v8, v23, v55, v8
    s_nop 2
    v_add_f32_dpp v8, v8, v8 quad_perm:[1,0,3,2] row_mask:0xf bank_mask:0xf
    s_nop 1
    v_add_f32_dpp v8, v8, v8 quad_perm:[2,3,0,1] row_mask:0xf bank_mask:0xf
    s_mov_b32 exec_lo, 0x11111111
    s_mov_b32 exec_hi, 0x11111111
    buffer_store_dword v8, v5, s[20:23], s31 offen sc1
    s_mov_b64 exec, -1
    v_cvt_pk_bf16_f32 v158, v114, v115
    v_cndmask_b32_dpp v186, v168, v170, vcc quad_perm:[2,3,0,1] row_mask:0xf bank_mask:0xf
    v_mul_f32 v116, v108, v74
    v_cndmask_b32_dpp v187, v169, v171, vcc quad_perm:[2,3,0,1] row_mask:0xf bank_mask:0xf
    v_mul_f32 v117, v108, v75
    v_cndmask_b32_dpp v190, v172, v174, vcc quad_perm:[2,3,0,1] row_mask:0xf bank_mask:0xf
    v_fmac_f32 v116, v109, v59
    v_cndmask_b32_dpp v191, v173, v175, vcc quad_perm:[2,3,0,1] row_mask:0xf bank_mask:0xf
    v_fmac_f32 v117, v109, v74
    v_cndmask_b32_dpp v194, v176, v178, vcc quad_perm:[2,3,0,1] row_mask:0xf bank_mask:0xf
    v_cvt_pk_bf16_f32 v159, v116, v117
    v_cndmask_b32_dpp v195, v177, v179, vcc quad_perm:[2,3,0,1] row_mask:0xf bank_mask:0xf
    v_mul_f32 v118, v102, v102
    v_cndmask_b32_dpp v198, v180, v182, vcc quad_perm:[2,3,0,1] row_mask:0xf bank_mask:0xf
    v_add_f32 v62, v102, v102
    v_cndmask_b32_dpp v199, v181, v183, vcc quad_perm:[2,3,0,1] row_mask:0xf bank_mask:0xf
    s_mov_b32 vcc_lo, 0x55555555
    s_mov_b32 vcc_hi, 0x55555555
    v_fma_f32 v118, -v103, v103, v118
    v_cndmask_b32_dpp v200, v185, v184, vcc quad_perm:[1,0,3,2] row_mask:0xf bank_mask:0xf
    v_mul_f32 v119, v62, v103
    v_cndmask_b32_dpp v202, v187, v186, vcc quad_perm:[1,0,3,2] row_mask:0xf bank_mask:0xf
    v_cvt_pk_bf16_f32 v160, v118, v119
    v_cndmask_b32_dpp v204, v189, v188, vcc quad_perm:[1,0,3,2] row_mask:0xf bank_mask:0xf
    v_mul_f32 v120, v104, v104
    v_cndmask_b32_dpp v206, v191, v190, vcc quad_perm:[1,0,3,2] row_mask:0xf bank_mask:0xf
    v_add_f32 v63, v104, v104
    v_cndmask_b32_dpp v208, v193, v192, vcc quad_perm:[1,0,3,2] row_mask:0xf bank_mask:0xf
    v_fma_f32 v120, -v105, v105, v120
    v_cndmask_b32_dpp v210, v195, v194, vcc quad_perm:[1,0,3,2] row_mask:0xf bank_mask:0xf
    v_mul_f32 v121, v63, v105
    v_cndmask_b32_dpp v212, v197, v196, vcc quad_perm:[1,0,3,2] row_mask:0xf bank_mask:0xf
    v_cvt_pk_bf16_f32 v161, v120, v121
    v_cndmask_b32_dpp v214, v199, v198, vcc quad_perm:[1,0,3,2] row_mask:0xf bank_mask:0xf
    s_not_b64 vcc, vcc
    v_mul_f32 v122, v110, v110
    v_cndmask_b32_dpp v201, v184, v185, vcc quad_perm:[1,0,3,2] row_mask:0xf bank_mask:0xf
    v_add_f32 v60, v110, v110
    v_cndmask_b32_dpp v203, v186, v187, vcc quad_perm:[1,0,3,2] row_mask:0xf bank_mask:0xf
    v_fma_f32 v122, -v111, v111, v122
    v_cndmask_b32_dpp v205, v188, v189, vcc quad_perm:[1,0,3,2] row_mask:0xf bank_mask:0xf
    v_mfma_f32_16x16x32_bf16 v[232:235], v[200:203], v[216:219], 0
    v_cndmask_b32_dpp v207, v190, v191, vcc quad_perm:[1,0,3,2] row_mask:0xf bank_mask:0xf
    v_mul_f32 v123, v60, v111
    v_cndmask_b32_dpp v209, v192, v193, vcc quad_perm:[1,0,3,2] row_mask:0xf bank_mask:0xf
    v_mfma_f32_16x16x32_bf16 v[232:235], v[204:207], v[220:223], v[232:235]
    v_cndmask_b32_dpp v211, v194, v195, vcc quad_perm:[1,0,3,2] row_mask:0xf bank_mask:0xf
    v_cvt_pk_bf16_f32 v164, v122, v123
    v_cndmask_b32_dpp v213, v196, v197, vcc quad_perm:[1,0,3,2] row_mask:0xf bank_mask:0xf
    v_mfma_f32_16x16x32_bf16 v[232:235], v[208:211], v[224:227], v[232:235]
    v_cndmask_b32_dpp v215, v198, v199, vcc quad_perm:[1,0,3,2] row_mask:0xf bank_mask:0xf
    s_mov_b32 vcc_lo, 0xff00ff
    s_mov_b32 vcc_hi, 0xff00ff
    v_mfma_f32_16x16x32_bf16 v[232:235], v[212:215], v[228:231], v[232:235]
    v_cndmask_b32_dpp v184, v160, v152, vcc row_ror:8 row_mask:0xf bank_mask:0xf
    v_mul_f32 v124, v112, v112
    v_cndmask_b32_dpp v185, v161, v153, vcc row_ror:8 row_mask:0xf bank_mask:0xf
    v_add_f32 v61, v112, v112
    v_cndmask_b32_dpp v188, v164, v156, vcc row_ror:8 row_mask:0xf bank_mask:0xf
    v_fma_f32 v124, -v113, v113, v124
    v_mul_f32 v125, v61, v113
    v_cvt_pk_bf16_f32 v165, v124, v125
    v_mul_f32 v126, v118, v74
    v_mul_f32 v127, v118, v75
    v_cndmask_b32_dpp v189, v165, v157, vcc row_ror:8 row_mask:0xf bank_mask:0xf
    v_fmac_f32 v126, v119, v59
    v_fmac_f32 v127, v119, v74
    v_cvt_pk_bf16_f32 v162, v126, v127
    v_mul_f32 v128, v120, v74
    v_mul_f32 v129, v120, v75
    v_cndmask_b32_dpp v186, v162, v154, vcc row_ror:8 row_mask:0xf bank_mask:0xf
    v_fmac_f32 v128, v121, v59
    v_fmac_f32 v129, v121, v74
    v_cvt_pk_bf16_f32 v163, v128, v129
    v_mul_f32 v130, v122, v74
    v_mul_f32 v131, v122, v75
    v_cndmask_b32_dpp v187, v163, v155, vcc row_ror:8 row_mask:0xf bank_mask:0xf
    v_fmac_f32 v130, v123, v59
    v_fmac_f32 v131, v123, v74
    v_cvt_pk_bf16_f32 v166, v130, v131
    v_mul_f32 v132, v124, v74
    v_mul_f32 v133, v124, v75
    v_cndmask_b32_dpp v190, v166, v158, vcc row_ror:8 row_mask:0xf bank_mask:0xf
    v_fmac_f32 v132, v125, v59
    v_fmac_f32 v133, v125, v74
    v_cvt_pk_bf16_f32 v167, v132, v133
    v_mul_f32 v134, v118, v118
    v_add_f32 v62, v118, v118
    v_cndmask_b32_dpp v191, v167, v159, vcc row_ror:8 row_mask:0xf bank_mask:0xf
    s_not_b64 vcc, vcc
    v_fma_f32 v134, -v119, v119, v134
    v_cndmask_b32_dpp v192, v152, v160, vcc row_ror:8 row_mask:0xf bank_mask:0xf
    v_mul_f32 v135, v62, v119
    v_cndmask_b32_dpp v193, v153, v161, vcc row_ror:8 row_mask:0xf bank_mask:0xf
    v_cvt_pk_bf16_f32 v168, v134, v135
    v_cndmask_b32_dpp v194, v154, v162, vcc row_ror:8 row_mask:0xf bank_mask:0xf
    v_mul_f32 v136, v126, v126
    v_cndmask_b32_dpp v195, v155, v163, vcc row_ror:8 row_mask:0xf bank_mask:0xf
    v_add_f32 v63, v126, v126
    v_cndmask_b32_dpp v196, v156, v164, vcc row_ror:8 row_mask:0xf bank_mask:0xf
    v_fma_f32 v136, -v127, v127, v136
    v_cndmask_b32_dpp v197, v157, v165, vcc row_ror:8 row_mask:0xf bank_mask:0xf
    v_mul_f32 v137, v63, v127
    v_cndmask_b32_dpp v198, v158, v166, vcc row_ror:8 row_mask:0xf bank_mask:0xf
    v_cvt_pk_bf16_f32 v170, v136, v137
    v_cndmask_b32_dpp v199, v159, v167, vcc row_ror:8 row_mask:0xf bank_mask:0xf
    s_mov_b32 vcc_lo, 0xf0f0f0f
    s_mov_b32 vcc_hi, 0xf0f0f0f
    v_mul_f32 v138, v122, v122
    v_cndmask_b32_dpp v152, v188, v184, vcc row_ror:4 row_mask:0xf bank_mask:0xf
    v_add_f32 v60, v122, v122
    v_cndmask_b32_dpp v153, v189, v185, vcc row_ror:4 row_mask:0xf bank_mask:0xf
    v_fma_f32 v138, -v123, v123, v138
    v_cndmask_b32_dpp v154, v190, v186, vcc row_ror:4 row_mask:0xf bank_mask:0xf
    v_mul_f32 v139, v60, v123
    v_cndmask_b32_dpp v155, v191, v187, vcc row_ror:4 row_mask:0xf bank_mask:0xf
    v_cvt_pk_bf16_f32 v172, v138, v139
    v_cndmask_b32_dpp v160, v196, v192, vcc row_ror:4 row_mask:0xf bank_mask:0xf
    v_mul_f32 v140, v130, v130
    v_cndmask_b32_dpp v161, v197, v193, vcc row_ror:4 row_mask:0xf bank_mask:0xf
    v_add_f32 v61, v130, v130
    v_cndmask_b32_dpp v162, v198, v194, vcc row_ror:4 row_mask:0xf bank_mask:0xf
    v_fma_f32 v140, -v131, v131, v140
    v_cndmask_b32_dpp v163, v199, v195, vcc row_ror:4 row_mask:0xf bank_mask:0xf
    s_not_b64 vcc, vcc
    v_mul_f32 v141, v61, v131
    v_cndmask_b32_dpp v156, v184, v188, vcc row_ror:12 row_mask:0xf bank_mask:0xf
    v_cvt_pk_bf16_f32 v174, v140, v141
    v_cndmask_b32_dpp v157, v185, v189, vcc row_ror:12 row_mask:0xf bank_mask:0xf
    v_mul_f32 v142, v134, v74
    v_cndmask_b32_dpp v158, v186, v190, vcc row_ror:12 row_mask:0xf bank_mask:0xf
    v_mul_f32 v143, v134, v75
    v_cndmask_b32_dpp v159, v187, v191, vcc row_ror:12 row_mask:0xf bank_mask:0xf
    v_fmac_f32 v142, v135, v59
    v_cndmask_b32_dpp v164, v192, v196, vcc row_ror:12 row_mask:0xf bank_mask:0xf
    v_fmac_f32 v143, v135, v74
    v_cndmask_b32_dpp v165, v193, v197, vcc row_ror:12 row_mask:0xf bank_mask:0xf
    v_cvt_pk_bf16_f32 v169, v142, v143
    v_cndmask_b32_dpp v166, v194, v198, vcc row_ror:12 row_mask:0xf bank_mask:0xf
    v_mul_f32 v144, v136, v74
    v_cndmask_b32_dpp v167, v195, v199, vcc row_ror:12 row_mask:0xf bank_mask:0xf
    s_mov_b32 vcc_lo, 0x33333333
    s_mov_b32 vcc_hi, 0x33333333
    v_mul_f32 v145, v136, v75
    v_cndmask_b32_dpp v184, v154, v152, vcc quad_perm:[2,3,0,1] row_mask:0xf bank_mask:0xf
    v_fmac_f32 v144, v137, v59
    v_cndmask_b32_dpp v185, v155, v153, vcc quad_perm:[2,3,0,1] row_mask:0xf bank_mask:0xf
    v_fmac_f32 v145, v137, v74
    v_cndmask_b32_dpp v188, v158, v156, vcc quad_perm:[2,3,0,1] row_mask:0xf bank_mask:0xf
    v_cvt_pk_bf16_f32 v171, v144, v145
    v_cndmask_b32_dpp v189, v159, v157, vcc quad_perm:[2,3,0,1] row_mask:0xf bank_mask:0xf
    v_mul_f32 v146, v138, v74
    v_cndmask_b32_dpp v192, v162, v160, vcc quad_perm:[2,3,0,1] row_mask:0xf bank_mask:0xf
    v_mul_f32 v147, v138, v75
    v_cndmask_b32_dpp v193, v163, v161, vcc quad_perm:[2,3,0,1] row_mask:0xf bank_mask:0xf
    v_fmac_f32 v146, v139, v59
    v_cndmask_b32_dpp v196, v166, v164, vcc quad_perm:[2,3,0,1] row_mask:0xf bank_mask:0xf
    v_fmac_f32 v147, v139, v74
    v_cndmask_b32_dpp v197, v167, v165, vcc quad_perm:[2,3,0,1] row_mask:0xf bank_mask:0xf
    s_not_b64 vcc, vcc
    v_cvt_pk_bf16_f32 v173, v146, v147
    v_cndmask_b32_dpp v186, v152, v154, vcc quad_perm:[2,3,0,1] row_mask:0xf bank_mask:0xf
    v_mul_f32 v148, v140, v74
    v_cndmask_b32_dpp v187, v153, v155, vcc quad_perm:[2,3,0,1] row_mask:0xf bank_mask:0xf
    v_mul_f32 v149, v140, v75
    v_cndmask_b32_dpp v190, v156, v158, vcc quad_perm:[2,3,0,1] row_mask:0xf bank_mask:0xf
    v_fmac_f32 v148, v141, v59
    v_cndmask_b32_dpp v191, v157, v159, vcc quad_perm:[2,3,0,1] row_mask:0xf bank_mask:0xf
    v_fmac_f32 v149, v141, v74
    v_cndmask_b32_dpp v194, v160, v162, vcc quad_perm:[2,3,0,1] row_mask:0xf bank_mask:0xf
    v_cvt_pk_bf16_f32 v175, v148, v149
    v_cndmask_b32_dpp v195, v161, v163, vcc quad_perm:[2,3,0,1] row_mask:0xf bank_mask:0xf
    v_mul_f32 v150, v134, v134
    v_cndmask_b32_dpp v198, v164, v166, vcc quad_perm:[2,3,0,1] row_mask:0xf bank_mask:0xf
    v_add_f32 v62, v134, v134
    v_cndmask_b32_dpp v199, v165, v167, vcc quad_perm:[2,3,0,1] row_mask:0xf bank_mask:0xf
    s_mov_b32 vcc_lo, 0x55555555
    s_mov_b32 vcc_hi, 0x55555555
    v_fma_f32 v150, -v135, v135, v150
    v_cndmask_b32_dpp v200, v185, v184, vcc quad_perm:[1,0,3,2] row_mask:0xf bank_mask:0xf
    v_mul_f32 v151, v62, v135
    v_cndmask_b32_dpp v202, v187, v186, vcc quad_perm:[1,0,3,2] row_mask:0xf bank_mask:0xf
    v_cvt_pk_bf16_f32 v176, v150, v151
    v_cndmask_b32_dpp v204, v189, v188, vcc quad_perm:[1,0,3,2] row_mask:0xf bank_mask:0xf
    v_and_b32 v32, 0xffff0000, v38
    v_cndmask_b32_dpp v206, v191, v190, vcc quad_perm:[1,0,3,2] row_mask:0xf bank_mask:0xf
    v_and_b32 v33, 0xffff0000, v39
    v_cndmask_b32_dpp v208, v193, v192, vcc quad_perm:[1,0,3,2] row_mask:0xf bank_mask:0xf
    v_and_b32 v34, 0xffff0000, v40
    v_cndmask_b32_dpp v210, v195, v194, vcc quad_perm:[1,0,3,2] row_mask:0xf bank_mask:0xf
    v_and_b32 v35, 0xffff0000, v41
    v_cndmask_b32_dpp v212, v197, v196, vcc quad_perm:[1,0,3,2] row_mask:0xf bank_mask:0xf
    v_and_b32 v36, 0xffff0000, v42
    v_cndmask_b32_dpp v214, v199, v198, vcc quad_perm:[1,0,3,2] row_mask:0xf bank_mask:0xf
    s_not_b64 vcc, vcc
    v_and_b32 v37, 0xffff0000, v43
    v_cndmask_b32_dpp v201, v184, v185, vcc quad_perm:[1,0,3,2] row_mask:0xf bank_mask:0xf
    v_mul_f32 v32, v44, v32
    v_cndmask_b32_dpp v203, v186, v187, vcc quad_perm:[1,0,3,2] row_mask:0xf bank_mask:0xf
    v_mul_f32 v33, v44, v33
    v_cndmask_b32_dpp v205, v188, v189, vcc quad_perm:[1,0,3,2] row_mask:0xf bank_mask:0xf
    v_mfma_f32_16x16x32_bf16 v[236:239], v[200:203], v[216:219], 0
    v_cndmask_b32_dpp v207, v190, v191, vcc quad_perm:[1,0,3,2] row_mask:0xf bank_mask:0xf
    v_mul_f32 v34, v44, v34
    v_cndmask_b32_dpp v209, v192, v193, vcc quad_perm:[1,0,3,2] row_mask:0xf bank_mask:0xf
    v_mfma_f32_16x16x32_bf16 v[236:239], v[204:207], v[220:223], v[236:239]
    v_cndmask_b32_dpp v211, v194, v195, vcc quad_perm:[1,0,3,2] row_mask:0xf bank_mask:0xf
    v_mov_b32_dpp v193, v169 row_ror:8 row_mask:0xf bank_mask:0xf
    s_waitcnt vmcnt(0)
    s_cmp_lg_u32 s96, 0
    s_cbranch_scc1 S_havetag
    s_mov_b32 s98, 65536
    v_mov_b32 v10, 0
SA_nl:
    buffer_load_dwordx2 v[8:9], v10, s[60:63], 0 offen sc1
    s_waitcnt vmcnt(0)
    v_readfirstlane_b32 s96, v8
    v_readfirstlane_b32 s97, v9
    s_sub_u32 s98, s98, 1
    s_cbranch_scc1 SA_nd
    s_cmp_eq_u32 s96, 0
    s_cbranch_scc0 SA_nd
    s_sleep 2
    s_branch SA_nl
SA_nd:
S_havetag:
    s_lshl_b32 s38, s27, 5
    s_add_u32 s38, s38, s26
    s_lshl_b32 s38, s38, 2
    s_add_u32 s38, s38, s24
    s_lshl_b32 s38, s38, 3
    s_add_u32 s38, s38, 16384
    v_mov_b32 v10, s38
    v_mov_b32 v8, s96
    v_mov_b32 v9, s97
    s_mov_b64 exec, 1
    buffer_store_dwordx2 v[8:9], v10, s[56:59], 0 offen sc1
    s_mov_b64 exec, -1
    v_cndmask_b32_dpp v213, v196, v197, vcc quad_perm:[1,0,3,2] row_mask:0xf bank_mask:0xf
    v_mfma_f32_16x16x32_bf16 v[236:239], v[208:211], v[224:227], v[236:239]
    v_cndmask_b32_dpp v215, v198, v199, vcc quad_perm:[1,0,3,2] row_mask:0xf bank_mask:0xf
    s_mov_b32 vcc_lo, 0xff00ff
    s_mov_b32 vcc_hi, 0xff00ff
    v_mfma_f32_16x16x32_bf16 v[236:239], v[212:215], v[228:231], v[236:239]
    v_cndmask_b32_dpp v184, v176, v168, vcc row_ror:8 row_mask:0xf bank_mask:0xf
    s_not_b64 vcc, vcc
    v_mov_b32_dpp v194, v170 row_ror:8 row_mask:0xf bank_mask:0xf
    v_cndmask_b32_dpp v192, v168, v176, vcc row_ror:8 row_mask:0xf bank_mask:0xf
    s_mov_b32 vcc_lo, 0xf0f0f0f
    s_mov_b32 vcc_hi, 0xf0f0f0f
    v_mov_b32_dpp v195, v171 row_ror:8 row_mask:0xf bank_mask:0xf
    v_cndmask_b32_dpp v168, v172, v184, vcc row_ror:4 row_mask:0xf bank_mask:0xf
    v_mov_b32_dpp v196, v172 row_ror:8 row_mask:0xf bank_mask:0xf
    s_cmp_ge_u32 s87, 4
    s_cbranch_scc1 S_wt0
    buffer_load_dword v3, v2, s[48:51], s85 offen
    s_add_u32 s85, s85, 131072
S_wt0:
    v_cndmask_b32_dpp v176, v173, v169, vcc row_ror:4 row_mask:0xf bank_mask:0xf
    v_mov_b32_dpp v197, v173 row_ror:8 row_mask:0xf bank_mask:0xf
    v_cndmask_b32_dpp v177, v174, v170, vcc row_ror:4 row_mask:0xf bank_mask:0xf
    v_mov_b32_dpp v198, v174 row_ror:8 row_mask:0xf bank_mask:0xf
    v_cndmask_b32_dpp v178, v175, v171, vcc row_ror:4 row_mask:0xf bank_mask:0xf
    v_mov_b32_dpp v199, v175 row_ror:8 row_mask:0xf bank_mask:0xf
    v_cndmask_b32_dpp v183, v196, v192, vcc row_ror:4 row_mask:0xf bank_mask:0xf
    v_mul_f32 v35, v44, v35
    v_cndmask_b32_dpp v185, v197, v193, vcc row_ror:4 row_mask:0xf bank_mask:0xf
    v_mul_f32 v45, 0x3fb8aa3b, v32
    v_cndmask_b32_dpp v186, v198, v194, vcc row_ror:4 row_mask:0xf bank_mask:0xf
    v_mul_f32 v46, 0x3e22f983, v33
    v_cndmask_b32_dpp v187, v199, v195, vcc row_ror:4 row_mask:0xf bank_mask:0xf
    s_not_b64 vcc, vcc
    v_mul_f32 v68, v36, v34
    v_cndmask_b32_dpp v179, v184, v172, vcc row_ror:12 row_mask:0xf bank_mask:0xf
    v_mul_f32 v69, v36, v35
    v_cndmask_b32_dpp v180, v169, v173, vcc row_ror:12 row_mask:0xf bank_mask:0xf
    v_fma_f32 v68, -v37, v35, v68
    v_cndmask_b32_dpp v181, v170, v174, vcc row_ror:12 row_mask:0xf bank_mask:0xf
    v_fmac_f32 v69, v37, v34
    v_cndmask_b32_dpp v182, v171, v175, vcc row_ror:12 row_mask:0xf bank_mask:0xf
    v_mul_f32 v60, 0x41000000, v45
    v_cndmask_b32_dpp v188, v192, v196, vcc row_ror:12 row_mask:0xf bank_mask:0xf
    v_mul_f32 v70, 0x41000000, v46
    v_cndmask_b32_dpp v189, v193, v197, vcc row_ror:12 row_mask:0xf bank_mask:0xf
    v_exp_f32 v60, v60
    v_cndmask_b32_dpp v190, v194, v198, vcc row_ror:12 row_mask:0xf bank_mask:0xf
    v_rndne_f32 v61, v70
    v_cndmask_b32_dpp v191, v195, v199, vcc row_ror:12 row_mask:0xf bank_mask:0xf
    s_mov_b32 vcc_lo, 0x33333333
    s_mov_b32 vcc_hi, 0x33333333
    v_sub_f32 v61, v70, v61
    v_cndmask_b32_dpp v169, v177, v168, vcc quad_perm:[2,3,0,1] row_mask:0xf bank_mask:0xf
    v_cos_f32 v70, v61
    v_cndmask_b32_dpp v170, v178, v176, vcc quad_perm:[2,3,0,1] row_mask:0xf bank_mask:0xf
    v_sin_f32 v71, v61
    v_cndmask_b32_dpp v173, v181, v179, vcc quad_perm:[2,3,0,1] row_mask:0xf bank_mask:0xf
    v_mul_f32 v70, v70, v60
    v_cndmask_b32_dpp v174, v182, v180, vcc quad_perm:[2,3,0,1] row_mask:0xf bank_mask:0xf
    v_mul_f32 v71, v71, v60
    v_cndmask_b32_dpp v192, v186, v183, vcc quad_perm:[2,3,0,1] row_mask:0xf bank_mask:0xf
    v_sub_f32 v47, 0, v71
    v_cndmask_b32_dpp v193, v187, v185, vcc quad_perm:[2,3,0,1] row_mask:0xf bank_mask:0xf
    v_exp_f32 v62, v45
    v_cndmask_b32_dpp v196, v190, v188, vcc quad_perm:[2,3,0,1] row_mask:0xf bank_mask:0xf
    v_rndne_f32 v63, v46
    v_cndmask_b32_dpp v197, v191, v189, vcc quad_perm:[2,3,0,1] row_mask:0xf bank_mask:0xf
    s_not_b64 vcc, vcc
    v_sub_f32 v63, v46, v63
    v_cndmask_b32_dpp v171, v168, v177, vcc quad_perm:[2,3,0,1] row_mask:0xf bank_mask:0xf
    v_cos_f32 v72, v63
    v_cndmask_b32_dpp v172, v176, v178, vcc quad_perm:[2,3,0,1] row_mask:0xf bank_mask:0xf
    v_sin_f32 v73, v63
    v_cndmask_b32_dpp v175, v179, v181, vcc quad_perm:[2,3,0,1] row_mask:0xf bank_mask:0xf
    v_mul_f32 v72, v72, v62
    v_cndmask_b32_dpp v184, v180, v182, vcc quad_perm:[2,3,0,1] row_mask:0xf bank_mask:0xf
    v_mul_f32 v73, v73, v62
    v_cndmask_b32_dpp v194, v183, v186, vcc quad_perm:[2,3,0,1] row_mask:0xf bank_mask:0xf
    v_sub_f32 v58, 0, v73
    v_cndmask_b32_dpp v195, v185, v187, vcc quad_perm:[2,3,0,1] row_mask:0xf bank_mask:0xf
    v_mul_f32 v64, 0x43000000, v45
    s_cmp_ge_u32 s87, 4
    s_cbranch_scc1 S_wt1
    buffer_load_dword v3, v2, s[48:51], s85 offen
    s_add_u32 s85, s85, 131072
S_wt1:
    v_cndmask_b32_dpp v198, v188, v190, vcc quad_perm:[2,3,0,1] row_mask:0xf bank_mask:0xf
    v_mul_f32 v74, 0x43000000, v46
    v_cndmask_b32_dpp v199, v189, v191, vcc quad_perm:[2,3,0,1] row_mask:0xf bank_mask:0xf
    s_mov_b32 vcc_lo, 0x55555555
    s_mov_b32 vcc_hi, 0x55555555
    v_exp_f32 v64, v64
    v_cndmask_b32_dpp v200, v170, v169, vcc quad_perm:[1,0,3,2] row_mask:0xf bank_mask:0xf
    v_rndne_f32 v65, v74
    v_cndmask_b32_dpp v202, v172, v171, vcc quad_perm:[1,0,3,2] row_mask:0xf bank_mask:0xf
    v_sub_f32 v65, v74, v65
    v_cndmask_b32_dpp v204, v174, v173, vcc quad_perm:[1,0,3,2] row_mask:0xf bank_mask:0xf
    v_cos_f32 v74, v65
    v_cndmask_b32_dpp v206, v184, v175, vcc quad_perm:[1,0,3,2] row_mask:0xf bank_mask:0xf
    v_sin_f32 v75, v65
    v_cndmask_b32_dpp v208, v193, v192, vcc quad_perm:[1,0,3,2] row_mask:0xf bank_mask:0xf
    v_mul_f32 v74, v74, v64
    v_cndmask_b32_dpp v210, v195, v194, vcc quad_perm:[1,0,3,2] row_mask:0xf bank_mask:0xf
    v_mul_f32 v75, v75, v64
    v_cndmask_b32_dpp v212, v197, v196, vcc quad_perm:[1,0,3,2] row_mask:0xf bank_mask:0xf
    v_sub_f32 v59, 0, v75
    v_cndmask_b32_dpp v214, v199, v198, vcc quad_perm:[1,0,3,2] row_mask:0xf bank_mask:0xf
    s_not_b64 vcc, vcc
    v_cvt_pk_bf16_f32 v152, v68, -v69
    v_cndmask_b32_dpp v201, v169, v170, vcc quad_perm:[1,0,3,2] row_mask:0xf bank_mask:0xf
    v_mul_f32 v56, v68, v70
    v_cndmask_b32_dpp v203, v171, v172, vcc quad_perm:[1,0,3,2] row_mask:0xf bank_mask:0xf
    v_mul_f32 v57, v68, v71
    v_cndmask_b32_dpp v205, v173, v174, vcc quad_perm:[1,0,3,2] row_mask:0xf bank_mask:0xf
    v_mfma_f32_16x16x32_bf16 v[240:243], v[200:203], v[216:219], 0
    v_cndmask_b32_dpp v207, v175, v184, vcc quad_perm:[1,0,3,2] row_mask:0xf bank_mask:0xf
    v_fmac_f32 v56, v69, v47
    v_cndmask_b32_dpp v209, v192, v193, vcc quad_perm:[1,0,3,2] row_mask:0xf bank_mask:0xf
    v_mfma_f32_16x16x32_bf16 v[240:243], v[204:207], v[220:223], v[240:243]
    v_cndmask_b32_dpp v211, v194, v195, vcc quad_perm:[1,0,3,2] row_mask:0xf bank_mask:0xf
    v_fmac_f32 v57, v69, v70
    v_cndmask_b32_dpp v213, v196, v197, vcc quad_perm:[1,0,3,2] row_mask:0xf bank_mask:0xf
    v_mfma_f32_16x16x32_bf16 v[240:243], v[208:211], v[224:227], v[240:243]
    v_cndmask_b32_dpp v215, v198, v199, vcc quad_perm:[1,0,3,2] row_mask:0xf bank_mask:0xf
    s_mov_b32 vcc_lo, 0xff00ff
    s_mov_b32 vcc_hi, 0xff00ff
    v_mfma_f32_16x16x32_bf16 v[240:243], v[212:215], v[228:231], v[240:243]
    v_cvt_pk_bf16_f32 v153, v56, -v57
    v_mul_f32 v68, v56, v70
    v_mul_f32 v69, v56, v71
    v_fmac_f32 v68, v57, v47
    v_fmac_f32 v69, v57, v70
    v_cvt_pk_bf16_f32 v154, v68, -v69
    v_mul_f32 v56, v68, v70
    v_mul_f32 v57, v68, v71
    v_fmac_f32 v56, v69, v47
    v_fmac_f32 v57, v69, v70
    v_cvt_pk_bf16_f32 v155, v56, -v57
    v_mul_f32 v68, v56, v70
    v_mul_f32 v69, v56, v71
    v_fmac_f32 v68, v57, v47
    v_fmac_f32 v69, v57, v70
    v_cvt_pk_bf16_f32 v156, v68, -v69
    v_mul_f32 v56, v68, v70
    v_mul_f32 v57, v68, v71
    v_fmac_f32 v56, v69, v47
    v_fmac_f32 v57, v69, v70
    v_cvt_pk_bf16_f32 v157, v56, -v57
    v_mul_f32 v68, v56, v70
    s_cmp_ge_u32 s87, 4
    s_cbranch_scc1 S_wt2
    buffer_load_dword v3, v2, s[48:51], s85 offen
    s_add_u32 s85, s85, 131072
S_wt2:
    v_mul_f32 v69, v56, v71
    v_fmac_f32 v68, v57, v47
    v_fmac_f32 v69, v57, v70
    v_cvt_pk_bf16_f32 v158, v68, -v69
    v_mul_f32 v56, v68, v70
    v_mul_f32 v57, v68, v71
    v_fmac_f32 v56, v69, v47
    v_fmac_f32 v57, v69, v70
    v_cvt_pk_bf16_f32 v159, v56, -v57
    v_mul_f32 v68, v56, v70
    v_mul_f32 v69, v56, v71
    v_fmac_f32 v68, v57, v47
    v_fmac_f32 v69, v57, v70
    v_cvt_pk_bf16_f32 v160, v68, -v69
    v_mul_f32 v56, v68, v70
    v_mul_f32 v57, v68, v71
    v_cndmask_b32_dpp v184, v160, v152, vcc row_ror:8 row_mask:0xf bank_mask:0xf
    v_fmac_f32 v56, v69, v47
    v_fmac_f32 v57, v69, v70
    v_cvt_pk_bf16_f32 v161, v56, -v57
    v_mul_f32 v68, v56, v70
    v_mul_f32 v69, v56, v71
    v_cndmask_b32_dpp v185, v161, v153, vcc row_ror:8 row_mask:0xf bank_mask:0xf
    v_fmac_f32 v68, v57, v47
    v_fmac_f32 v69, v57, v70
    v_cvt_pk_bf16_f32 v162, v68, -v69
    v_mul_f32 v56, v68, v70
    v_mul_f32 v57, v68, v71
    v_cndmask_b32_dpp v186, v162, v154, vcc row_ror:8 row_mask:0xf bank_mask:0xf
    v_fmac_f32 v56, v69, v47
    v_fmac_f32 v57, v69, v70
    v_cvt_pk_bf16_f32 v163, v56, -v57
    v_mul_f32 v68, v56, v70
    v_mul_f32 v69, v56, v71
    v_cndmask_b32_dpp v187, v163, v155, vcc row_ror:8 row_mask:0xf bank_mask:0xf
    v_fmac_f32 v68, v57, v47
    v_fmac_f32 v69, v57, v70
    v_cvt_pk_bf16_f32 v164, v68, -v69
    v_mul_f32 v56, v68, v70
    v_mul_f32 v57, v68, v71
    v_cndmask_b32_dpp v188, v164, v156, vcc row_ror:8 row_mask:0xf bank_mask:0xf
    v_fmac_f32 v56, v69, v47
    v_fmac_f32 v57, v69, v70
    v_cvt_pk_bf16_f32 v165, v56, -v57
    v_mul_f32 v68, v56, v70
    v_mul_f32 v69, v56, v71
    v_cndmask_b32_dpp v189, v165, v157, vcc row_ror:8 row_mask:0xf bank_mask:0xf
    v_fmac_f32 v68, v57, v47
    v_fmac_f32 v69, v57, v70
    v_cvt_pk_bf16_f32 v166, v68, -v69
    v_mul_f32 v56, v68, v70
    v_mul_f32 v57, v68, v71
    v_cndmask_b32_dpp v190, v166, v158, vcc row_ror:8 row_mask:0xf bank_mask:0xf
    v_fmac_f32 v56, v69, v47
    v_fmac_f32 v57, v69, v70
    v_cvt_pk_bf16_f32 v167, v56, -v57
    v_mul_f32 v76, v72, v72
    v_mul_f32 v77, v72, v73
    v_cndmask_b32_dpp v191, v167, v159, vcc row_ror:8 row_mask:0xf bank_mask:0xf
    s_not_b64 vcc, vcc
    v_fmac_f32 v76, v73, v58
    v_cndmask_b32_dpp v192, v152, v160, vcc row_ror:8 row_mask:0xf bank_mask:0xf
    s_cmp_ge_u32 s87, 4
    s_cbranch_scc1 S_wt3
    buffer_load_dword v3, v2, s[48:51], s85 offen
    s_add_u32 s85, s85, 131072
S_wt3:
    v_fmac_f32 v77, v73, v72
    v_cndmask_b32_dpp v193, v153, v161, vcc row_ror:8 row_mask:0xf bank_mask:0xf
    v_mul_f32 v78, v76, v72
    v_cndmask_b32_dpp v194, v154, v162, vcc row_ror:8 row_mask:0xf bank_mask:0xf
    v_mul_f32 v79, v76, v73
    v_cndmask_b32_dpp v195, v155, v163, vcc row_ror:8 row_mask:0xf bank_mask:0xf
    v_fmac_f32 v78, v77, v58
    v_cndmask_b32_dpp v196, v156, v164, vcc row_ror:8 row_mask:0xf bank_mask:0xf
    v_fmac_f32 v79, v77, v72
    v_cndmask_b32_dpp v197, v157, v165, vcc row_ror:8 row_mask:0xf bank_mask:0xf
    v_mul_f32 v80, v78, v72
    v_cndmask_b32_dpp v198, v158, v166, vcc row_ror:8 row_mask:0xf bank_mask:0xf
    v_mul_f32 v81, v78, v73
    v_cndmask_b32_dpp v199, v159, v167, vcc row_ror:8 row_mask:0xf bank_mask:0xf
    s_mov_b32 vcc_lo, 0xf0f0f0f
    s_mov_b32 vcc_hi, 0xf0f0f0f
    v_fmac_f32 v80, v79, v58
    v_cndmask_b32_dpp v152, v188, v184, vcc row_ror:4 row_mask:0xf bank_mask:0xf
    v_fmac_f32 v81, v79, v72
    v_cndmask_b32_dpp v153, v189, v185, vcc row_ror:4 row_mask:0xf bank_mask:0xf
    v_mul_f32 v82, v80, v72
    v_cndmask_b32_dpp v154, v190, v186, vcc row_ror:4 row_mask:0xf bank_mask:0xf
    v_mul_f32 v83, v80, v73
    v_cndmask_b32_dpp v155, v191, v187, vcc row_ror:4 row_mask:0xf bank_mask:0xf
    v_fmac_f32 v82, v81, v58
    v_cndmask_b32_dpp v160, v196, v192, vcc row_ror:4 row_mask:0xf bank_mask:0xf
    v_fmac_f32 v83, v81, v72
    v_cndmask_b32_dpp v161, v197, v193, vcc row_ror:4 row_mask:0xf bank_mask:0xf
    v_mul_f32 v84, v82, v72
    v_cndmask_b32_dpp v162, v198, v194, vcc row_ror:4 row_mask:0xf bank_mask:0xf
    v_mul_f32 v85, v82, v73
    v_cndmask_b32_dpp v163, v199, v195, vcc row_ror:4 row_mask:0xf bank_mask:0xf
    s_not_b64 vcc, vcc
    v_fmac_f32 v84, v83, v58
    v_cndmask_b32_dpp v156, v184, v188, vcc row_ror:12 row_mask:0xf bank_mask:0xf
    v_fmac_f32 v85, v83, v72
    v_cndmask_b32_dpp v157, v185, v189, vcc row_ror:12 row_mask:0xf bank_mask:0xf
    v_mul_f32 v86, v84, v72
    v_cndmask_b32_dpp v158, v186, v190, vcc row_ror:12 row_mask:0xf bank_mask:0xf
    v_mul_f32 v87, v84, v73
    v_cndmask_b32_dpp v159, v187, v191, vcc row_ror:12 row_mask:0xf bank_mask:0xf
    v_fmac_f32 v86, v85, v58
    v_cndmask_b32_dpp v164, v192, v196, vcc row_ror:12 row_mask:0xf bank_mask:0xf
    v_fmac_f32 v87, v85, v72
    v_cndmask_b32_dpp v165, v193, v197, vcc row_ror:12 row_mask:0xf bank_mask:0xf
    v_mul_f32 v88, v72, v74
    v_cndmask_b32_dpp v166, v194, v198, vcc row_ror:12 row_mask:0xf bank_mask:0xf
    v_mul_f32 v89, v72, v75
    v_cndmask_b32_dpp v167, v195, v199, vcc row_ror:12 row_mask:0xf bank_mask:0xf
    s_mov_b32 vcc_lo, 0x33333333
    s_mov_b32 vcc_hi, 0x33333333
    v_fmac_f32 v88, v73, v59
    v_cndmask_b32_dpp v184, v154, v152, vcc quad_perm:[2,3,0,1] row_mask:0xf bank_mask:0xf
    v_fmac_f32 v89, v73, v74
    v_cndmask_b32_dpp v185, v155, v153, vcc quad_perm:[2,3,0,1] row_mask:0xf bank_mask:0xf
    v_mul_f32 v90, v76, v74
    v_cndmask_b32_dpp v188, v158, v156, vcc quad_perm:[2,3,0,1] row_mask:0xf bank_mask:0xf
    v_mul_f32 v91, v76, v75
    v_cndmask_b32_dpp v189, v159, v157, vcc quad_perm:[2,3,0,1] row_mask:0xf bank_mask:0xf
    v_fmac_f32 v90, v77, v59
    v_cndmask_b32_dpp v192, v162, v160, vcc quad_perm:[2,3,0,1] row_mask:0xf bank_mask:0xf
    v_fmac_f32 v91, v77, v74
    s_cmp_ge_u32 s87, 4
    s_cbranch_scc1 S_wt4
    buffer_load_dword v3, v2, s[48:51], s85 offen
    s_add_u32 s85, s85, 131072
S_wt4:
    v_cndmask_b32_dpp v193, v163, v161, vcc quad_perm:[2,3,0,1] row_mask:0xf bank_mask:0xf
    v_mul_f32 v92, v78, v74
    v_cndmask_b32_dpp v196, v166, v164, vcc quad_perm:[2,3,0,1] row_mask:0xf bank_mask:0xf
    v_mul_f32 v93, v78, v75
    v_cndmask_b32_dpp v197, v167, v165, vcc quad_perm:[2,3,0,1] row_mask:0xf bank_mask:0xf
    s_not_b64 vcc, vcc
    v_fmac_f32 v92, v79, v59
    v_cndmask_b32_dpp v186, v152, v154, vcc quad_perm:[2,3,0,1] row_mask:0xf bank_mask:0xf
    v_fmac_f32 v93, v79, v74
    v_cndmask_b32_dpp v187, v153, v155, vcc quad_perm:[2,3,0,1] row_mask:0xf bank_mask:0xf
    v_mul_f32 v94, v80, v74
    v_cndmask_b32_dpp v190, v156, v158, vcc quad_perm:[2,3,0,1] row_mask:0xf bank_mask:0xf
    v_mul_f32 v95, v80, v75
    v_cndmask_b32_dpp v191, v157, v159, vcc quad_perm:[2,3,0,1] row_mask:0xf bank_mask:0xf
    v_fmac_f32 v94, v81, v59
    v_cndmask_b32_dpp v194, v160, v162, vcc quad_perm:[2,3,0,1] row_mask:0xf bank_mask:0xf
    v_fmac_f32 v95, v81, v74
    v_cndmask_b32_dpp v195, v161, v163, vcc quad_perm:[2,3,0,1] row_mask:0xf bank_mask:0xf
    v_mul_f32 v96, v82, v74
    v_cndmask_b32_dpp v198, v164, v166, vcc quad_perm:[2,3,0,1] row_mask:0xf bank_mask:0xf
    v_mul_f32 v97, v82, v75
    v_cndmask_b32_dpp v199, v165, v167, vcc quad_perm:[2,3,0,1] row_mask:0xf bank_mask:0xf
    s_mov_b32 vcc_lo, 0x55555555
    s_mov_b32 vcc_hi, 0x55555555
    v_fmac_f32 v96, v83, v59
    v_cndmask_b32_dpp v216, v185, v184, vcc quad_perm:[1,0,3,2] row_mask:0xf bank_mask:0xf
    v_fmac_f32 v97, v83, v74
    v_cndmask_b32_dpp v218, v187, v186, vcc quad_perm:[1,0,3,2] row_mask:0xf bank_mask:0xf
    v_mul_f32 v98, v84, v74
    v_cndmask_b32_dpp v220, v189, v188, vcc quad_perm:[1,0,3,2] row_mask:0xf bank_mask:0xf
    v_mul_f32 v99, v84, v75
    v_cndmask_b32_dpp v222, v191, v190, vcc quad_perm:[1,0,3,2] row_mask:0xf bank_mask:0xf
    v_fmac_f32 v98, v85, v59
    v_cndmask_b32_dpp v224, v193, v192, vcc quad_perm:[1,0,3,2] row_mask:0xf bank_mask:0xf
    v_fmac_f32 v99, v85, v74
    v_cndmask_b32_dpp v226, v195, v194, vcc quad_perm:[1,0,3,2] row_mask:0xf bank_mask:0xf
    v_mul_f32 v100, v86, v74
    v_cndmask_b32_dpp v228, v197, v196, vcc quad_perm:[1,0,3,2] row_mask:0xf bank_mask:0xf
    v_mul_f32 v101, v86, v75
    v_cndmask_b32_dpp v230, v199, v198, vcc quad_perm:[1,0,3,2] row_mask:0xf bank_mask:0xf
    s_not_b64 vcc, vcc
    v_fmac_f32 v100, v87, v59
    v_cndmask_b32_dpp v217, v184, v185, vcc quad_perm:[1,0,3,2] row_mask:0xf bank_mask:0xf
    v_fmac_f32 v101, v87, v74
    v_cndmask_b32_dpp v219, v186, v187, vcc quad_perm:[1,0,3,2] row_mask:0xf bank_mask:0xf
    v_mov_b32 v168, 0x3f80
    v_cndmask_b32_dpp v221, v188, v189, vcc quad_perm:[1,0,3,2] row_mask:0xf bank_mask:0xf
    v_cvt_pk_bf16_f32 v169, v72, v73
    v_cndmask_b32_dpp v223, v190, v191, vcc quad_perm:[1,0,3,2] row_mask:0xf bank_mask:0xf
    v_cvt_pk_bf16_f32 v170, v76, v77
    v_cndmask_b32_dpp v225, v192, v193, vcc quad_perm:[1,0,3,2] row_mask:0xf bank_mask:0xf
    v_cvt_pk_bf16_f32 v171, v78, v79
    v_cndmask_b32_dpp v227, v194, v195, vcc quad_perm:[1,0,3,2] row_mask:0xf bank_mask:0xf
    v_cvt_pk_bf16_f32 v172, v80, v81
    v_cndmask_b32_dpp v229, v196, v197, vcc quad_perm:[1,0,3,2] row_mask:0xf bank_mask:0xf
    v_cvt_pk_bf16_f32 v173, v82, v83
    v_cndmask_b32_dpp v231, v198, v199, vcc quad_perm:[1,0,3,2] row_mask:0xf bank_mask:0xf
    s_mov_b32 vcc_lo, 0xff00ff
    s_mov_b32 vcc_hi, 0xff00ff
    v_cvt_pk_bf16_f32 v174, v84, v85
    v_cvt_pk_bf16_f32 v175, v86, v87
    v_cvt_pk_bf16_f32 v176, v74, v75
    v_cvt_pk_bf16_f32 v177, v88, v89
    s_cmp_ge_u32 s87, 4
    s_cbranch_scc1 S_wt5
    buffer_load_dword v3, v2, s[48:51], s85 offen
    s_add_u32 s85, s85, 131072
S_wt5:
    v_cvt_pk_bf16_f32 v178, v90, v91
    v_cndmask_b32_dpp v184, v176, v168, vcc row_ror:8 row_mask:0xf bank_mask:0xf
    v_cvt_pk_bf16_f32 v179, v92, v93
    v_cndmask_b32_dpp v185, v177, v169, vcc row_ror:8 row_mask:0xf bank_mask:0xf
    v_cvt_pk_bf16_f32 v180, v94, v95
    v_cndmask_b32_dpp v186, v178, v170, vcc row_ror:8 row_mask:0xf bank_mask:0xf
    v_cvt_pk_bf16_f32 v181, v96, v97
    v_cndmask_b32_dpp v187, v179, v171, vcc row_ror:8 row_mask:0xf bank_mask:0xf
    v_cvt_pk_bf16_f32 v182, v98, v99
    v_cndmask_b32_dpp v188, v180, v172, vcc row_ror:8 row_mask:0xf bank_mask:0xf
    v_cvt_pk_bf16_f32 v183, v100, v101
    v_cndmask_b32_dpp v189, v181, v173, vcc row_ror:8 row_mask:0xf bank_mask:0xf
    v_mul_f32 v102, v74, v74
    v_cndmask_b32_dpp v190, v182, v174, vcc row_ror:8 row_mask:0xf bank_mask:0xf
    v_mul_f32 v103, v74, v75
    v_cndmask_b32_dpp v191, v183, v175, vcc row_ror:8 row_mask:0xf bank_mask:0xf
    s_not_b64 vcc, vcc
    v_fmac_f32 v102, v75, v59
    v_cndmask_b32_dpp v192, v168, v176, vcc row_ror:8 row_mask:0xf bank_mask:0xf
    v_fmac_f32 v103, v75, v74
    v_cndmask_b32_dpp v193, v169, v177, vcc row_ror:8 row_mask:0xf bank_mask:0xf
    v_cvt_pk_bf16_f32 v152, v102, v103
    v_cndmask_b32_dpp v194, v170, v178, vcc row_ror:8 row_mask:0xf bank_mask:0xf
    v_mul_f32 v104, v88, v88
    v_cndmask_b32_dpp v195, v171, v179, vcc row_ror:8 row_mask:0xf bank_mask:0xf
    v_add_f32 v61, v88, v88
    v_cndmask_b32_dpp v196, v172, v180, vcc row_ror:8 row_mask:0xf bank_mask:0xf
    v_fma_f32 v104, -v89, v89, v104
    v_cndmask_b32_dpp v197, v173, v181, vcc row_ror:8 row_mask:0xf bank_mask:0xf
    v_mul_f32 v105, v61, v89
    v_cndmask_b32_dpp v198, v174, v182, vcc row_ror:8 row_mask:0xf bank_mask:0xf
    v_cvt_pk_bf16_f32 v153, v104, v105
    v_cndmask_b32_dpp v199, v175, v183, vcc row_ror:8 row_mask:0xf bank_mask:0xf
    s_mov_b32 vcc_lo, 0xf0f0f0f
    s_mov_b32 vcc_hi, 0xf0f0f0f
    v_mul_f32 v106, v90, v90
    v_cndmask_b32_dpp v168, v188, v184, vcc row_ror:4 row_mask:0xf bank_mask:0xf
    v_add_f32 v62, v90, v90
    v_cndmask_b32_dpp v169, v189, v185, vcc row_ror:4 row_mask:0xf bank_mask:0xf
    v_fma_f32 v106, -v91, v91, v106
    v_cndmask_b32_dpp v170, v190, v186, vcc row_ror:4 row_mask:0xf bank_mask:0xf
    v_mul_f32 v107, v62, v91
    v_cndmask_b32_dpp v171, v191, v187, vcc row_ror:4 row_mask:0xf bank_mask:0xf
    v_cvt_pk_bf16_f32 v154, v106, v107
    v_cndmask_b32_dpp v176, v196, v192, vcc row_ror:4 row_mask:0xf bank_mask:0xf
    v_mul_f32 v108, v92, v92
    v_cndmask_b32_dpp v177, v197, v193, vcc row_ror:4 row_mask:0xf bank_mask:0xf
    v_add_f32 v63, v92, v92
    v_cndmask_b32_dpp v178, v198, v194, vcc row_ror:4 row_mask:0xf bank_mask:0xf
    v_fma_f32 v108, -v93, v93, v108
    v_cndmask_b32_dpp v179, v199, v195, vcc row_ror:4 row_mask:0xf bank_mask:0xf
    s_not_b64 vcc, vcc
    v_mul_f32 v109, v63, v93
    v_cndmask_b32_dpp v172, v184, v188, vcc row_ror:12 row_mask:0xf bank_mask:0xf
    v_cvt_pk_bf16_f32 v155, v108, v109
    v_cndmask_b32_dpp v173, v185, v189, vcc row_ror:12 row_mask:0xf bank_mask:0xf
    v_mul_f32 v110, v102, v74
    v_cndmask_b32_dpp v174, v186, v190, vcc row_ror:12 row_mask:0xf bank_mask:0xf
    v_mul_f32 v111, v102, v75
    v_cndmask_b32_dpp v175, v187, v191, vcc row_ror:12 row_mask:0xf bank_mask:0xf
    v_fmac_f32 v110, v103, v59
    v_cndmask_b32_dpp v180, v192, v196, vcc row_ror:12 row_mask:0xf bank_mask:0xf
    s_cmp_ge_u32 s87, 4
    s_cbranch_scc1 S_wt6
    buffer_load_dword v3, v2, s[48:51], s85 offen
    s_add_u32 s85, s85, 131072
S_wt6:
    v_fmac_f32 v111, v103, v74
    v_cndmask_b32_dpp v181, v193, v197, vcc row_ror:12 row_mask:0xf bank_mask:0xf
    v_cvt_pk_bf16_f32 v156, v110, v111
    v_cndmask_b32_dpp v182, v194, v198, vcc row_ror:12 row_mask:0xf bank_mask:0xf
    v_mul_f32 v112, v104, v74
    v_cndmask_b32_dpp v183, v195, v199, vcc row_ror:12 row_mask:0xf bank_mask:0xf
    s_mov_b32 vcc_lo, 0x33333333
    s_mov_b32 vcc_hi, 0x33333333
    v_mul_f32 v113, v104, v75
    v_cndmask_b32_dpp v184, v170, v168, vcc quad_perm:[2,3,0,1] row_mask:0xf bank_mask:0xf
    v_fmac_f32 v112, v105, v59
    v_cndmask_b32_dpp v185, v171, v169, vcc quad_perm:[2,3,0,1] row_mask:0xf bank_mask:0xf
    v_fmac_f32 v113, v105, v74
    v_cndmask_b32_dpp v188, v174, v172, vcc quad_perm:[2,3,0,1] row_mask:0xf bank_mask:0xf
    v_cvt_pk_bf16_f32 v157, v112, v113
    v_cndmask_b32_dpp v189, v175, v173, vcc quad_perm:[2,3,0,1] row_mask:0xf bank_mask:0xf
    v_mul_f32 v114, v106, v74
    v_cndmask_b32_dpp v192, v178, v176, vcc quad_perm:[2,3,0,1] row_mask:0xf bank_mask:0xf
    v_mul_f32 v115, v106, v75
    v_cndmask_b32_dpp v193, v179, v177, vcc quad_perm:[2,3,0,1] row_mask:0xf bank_mask:0xf
    v_fmac_f32 v114, v107, v59
    v_cndmask_b32_dpp v196, v182, v180, vcc quad_perm:[2,3,0,1] row_mask:0xf bank_mask:0xf
    v_fmac_f32 v115, v107, v74
    v_cndmask_b32_dpp v197, v183, v181, vcc quad_perm:[2,3,0,1] row_mask:0xf bank_mask:0xf
    s_not_b64 vcc, vcc
    v_cvt_pk_bf16_f32 v158, v114, v115
    v_cndmask_b32_dpp v186, v168, v170, vcc quad_perm:[2,3,0,1] row_mask:0xf bank_mask:0xf
    v_mul_f32 v116, v108, v74
    v_cndmask_b32_dpp v187, v169, v171, vcc quad_perm:[2,3,0,1] row_mask:0xf bank_mask:0xf
    v_mul_f32 v117, v108, v75
    v_cndmask_b32_dpp v190, v172, v174, vcc quad_perm:[2,3,0,1] row_mask:0xf bank_mask:0xf
    v_fmac_f32 v116, v109, v59
    v_cndmask_b32_dpp v191, v173, v175, vcc quad_perm:[2,3,0,1] row_mask:0xf bank_mask:0xf
    v_fmac_f32 v117, v109, v74
    v_cndmask_b32_dpp v194, v176, v178, vcc quad_perm:[2,3,0,1] row_mask:0xf bank_mask:0xf
    v_cvt_pk_bf16_f32 v159, v116, v117
    v_cndmask_b32_dpp v195, v177, v179, vcc quad_perm:[2,3,0,1] row_mask:0xf bank_mask:0xf
    v_mul_f32 v118, v102, v102
    v_cndmask_b32_dpp v198, v180, v182, vcc quad_perm:[2,3,0,1] row_mask:0xf bank_mask:0xf
    v_add_f32 v60, v102, v102
    v_cndmask_b32_dpp v199, v181, v183, vcc quad_perm:[2,3,0,1] row_mask:0xf bank_mask:0xf
    s_mov_b32 vcc_lo, 0x55555555
    s_mov_b32 vcc_hi, 0x55555555
    v_fma_f32 v118, -v103, v103, v118
    v_cndmask_b32_dpp v200, v185, v184, vcc quad_perm:[1,0,3,2] row_mask:0xf bank_mask:0xf
    v_mul_f32 v119, v60, v103
    v_cndmask_b32_dpp v202, v187, v186, vcc quad_perm:[1,0,3,2] row_mask:0xf bank_mask:0xf
    v_cvt_pk_bf16_f32 v160, v118, v119
    v_cndmask_b32_dpp v204, v189, v188, vcc quad_perm:[1,0,3,2] row_mask:0xf bank_mask:0xf
    v_mul_f32 v120, v104, v104
    v_cndmask_b32_dpp v206, v191, v190, vcc quad_perm:[1,0,3,2] row_mask:0xf bank_mask:0xf
    v_add_f32 v61, v104, v104
    v_cndmask_b32_dpp v208, v193, v192, vcc quad_perm:[1,0,3,2] row_mask:0xf bank_mask:0xf
    v_fma_f32 v120, -v105, v105, v120
    v_cndmask_b32_dpp v210, v195, v194, vcc quad_perm:[1,0,3,2] row_mask:0xf bank_mask:0xf
    v_mul_f32 v121, v61, v105
    v_cndmask_b32_dpp v212, v197, v196, vcc quad_perm:[1,0,3,2] row_mask:0xf bank_mask:0xf
    v_cvt_pk_bf16_f32 v161, v120, v121
    v_cndmask_b32_dpp v214, v199, v198, vcc quad_perm:[1,0,3,2] row_mask:0xf bank_mask:0xf
    s_not_b64 vcc, vcc
    v_mul_f32 v122, v110, v110
    v_cndmask_b32_dpp v201, v184, v185, vcc quad_perm:[1,0,3,2] row_mask:0xf bank_mask:0xf
    v_add_f32 v62, v110, v110
    s_cmp_ge_u32 s87, 4
    s_cbranch_scc1 S_wt7
    buffer_load_dword v3, v2, s[48:51], s85 offen
    s_add_u32 s85, s85, 131072
S_wt7:
    v_cndmask_b32_dpp v203, v186, v187, vcc quad_perm:[1,0,3,2] row_mask:0xf bank_mask:0xf
    v_fma_f32 v122, -v111, v111, v122
    v_cndmask_b32_dpp v205, v188, v189, vcc quad_perm:[1,0,3,2] row_mask:0xf bank_mask:0xf
    v_mfma_f32_16x16x32_bf16 v[232:235], v[200:203], v[216:219], v[232:235]
    v_cndmask_b32_dpp v207, v190, v191, vcc quad_perm:[1,0,3,2] row_mask:0xf bank_mask:0xf
    v_mul_f32 v123, v62, v111
    v_cndmask_b32_dpp v209, v192, v193, vcc quad_perm:[1,0,3,2] row_mask:0xf bank_mask:0xf
    v_mfma_f32_16x16x32_bf16 v[232:235], v[204:207], v[220:223], v[232:235]
    v_cndmask_b32_dpp v211, v194, v195, vcc quad_perm:[1,0,3,2] row_mask:0xf bank_mask:0xf
    v_cvt_pk_bf16_f32 v164, v122, v123
    v_cndmask_b32_dpp v213, v196, v197, vcc quad_perm:[1,0,3,2] row_mask:0xf bank_mask:0xf
    v_mfma_f32_16x16x32_bf16 v[232:235], v[208:211], v[224:227], v[232:235]
    v_cndmask_b32_dpp v215, v198, v199, vcc quad_perm:[1,0,3,2] row_mask:0xf bank_mask:0xf
    s_mov_b32 vcc_lo, 0xff00ff
    s_mov_b32 vcc_hi, 0xff00ff
    v_mfma_f32_16x16x32_bf16 v[232:235], v[212:215], v[228:231], v[232:235]
    v_cndmask_b32_dpp v184, v160, v152, vcc row_ror:8 row_mask:0xf bank_mask:0xf
    v_mul_f32 v124, v112, v112
    v_cndmask_b32_dpp v185, v161, v153, vcc row_ror:8 row_mask:0xf bank_mask:0xf
    v_add_f32 v63, v112, v112
    v_cndmask_b32_dpp v188, v164, v156, vcc row_ror:8 row_mask:0xf bank_mask:0xf
    v_fma_f32 v124, -v113, v113, v124
    v_mul_f32 v125, v63, v113
    v_cvt_pk_bf16_f32 v165, v124, v125
    v_mul_f32 v126, v118, v74
    v_mul_f32 v127, v118, v75
    v_cndmask_b32_dpp v189, v165, v157, vcc row_ror:8 row_mask:0xf bank_mask:0xf
    v_fmac_f32 v126, v119, v59
    v_fmac_f32 v127, v119, v74
    v_cvt_pk_bf16_f32 v162, v126, v127
    v_mul_f32 v128, v120, v74
    v_mul_f32 v129, v120, v75
    v_cndmask_b32_dpp v186, v162, v154, vcc row_ror:8 row_mask:0xf bank_mask:0xf
    v_fmac_f32 v128, v121, v59
    v_fmac_f32 v129, v121, v74
    v_cvt_pk_bf16_f32 v163, v128, v129
    v_mul_f32 v130, v122, v74
    v_mul_f32 v131, v122, v75
    v_cndmask_b32_dpp v187, v163, v155, vcc row_ror:8 row_mask:0xf bank_mask:0xf
    v_fmac_f32 v130, v123, v59
    v_fmac_f32 v131, v123, v74
    v_cvt_pk_bf16_f32 v166, v130, v131
    v_mul_f32 v132, v124, v74
    v_mul_f32 v133, v124, v75
    v_cndmask_b32_dpp v190, v166, v158, vcc row_ror:8 row_mask:0xf bank_mask:0xf
    v_fmac_f32 v132, v125, v59
    v_fmac_f32 v133, v125, v74
    v_cvt_pk_bf16_f32 v167, v132, v133
    v_mul_f32 v134, v118, v118
    v_add_f32 v60, v118, v118
    v_cndmask_b32_dpp v191, v167, v159, vcc row_ror:8 row_mask:0xf bank_mask:0xf
    s_not_b64 vcc, vcc
    v_fma_f32 v134, -v119, v119, v134
    v_cndmask_b32_dpp v192, v152, v160, vcc row_ror:8 row_mask:0xf bank_mask:0xf
    v_mul_f32 v135, v60, v119
    v_cndmask_b32_dpp v193, v153, v161, vcc row_ror:8 row_mask:0xf bank_mask:0xf
    v_cvt_pk_bf16_f32 v168, v134, v135
    v_cndmask_b32_dpp v194, v154, v162, vcc row_ror:8 row_mask:0xf bank_mask:0xf
    v_mul_f32 v136, v126, v126
    v_cndmask_b32_dpp v195, v155, v163, vcc row_ror:8 row_mask:0xf bank_mask:0xf
    v_add_f32 v61, v126, v126
    v_cndmask_b32_dpp v196, v156, v164, vcc row_ror:8 row_mask:0xf bank_mask:0xf
    s_cmp_ge_u32 s87, 4
    s_cbranch_scc1 S_wt8
    buffer_load_dword v3, v2, s[48:51], s85 offen
    s_add_u32 s85, s85, 131072
S_wt8:
    v_fma_f32 v136, -v127, v127, v136
    v_cndmask_b32_dpp v197, v157, v165, vcc row_ror:8 row_mask:0xf bank_mask:0xf
    v_mul_f32 v137, v61, v127
    v_cndmask_b32_dpp v198, v158, v166, vcc row_ror:8 row_mask:0xf bank_mask:0xf
    v_cvt_pk_bf16_f32 v170, v136, v137
    v_cndmask_b32_dpp v199, v159, v167, vcc row_ror:8 row_mask:0xf bank_mask:0xf
    s_mov_b32 vcc_lo, 0xf0f0f0f
    s_mov_b32 vcc_hi, 0xf0f0f0f
    v_mul_f32 v138, v122, v122
    v_cndmask_b32_dpp v152, v188, v184, vcc row_ror:4 row_mask:0xf bank_mask:0xf
    v_add_f32 v62, v122, v122
    v_cndmask_b32_dpp v153, v189, v185, vcc row_ror:4 row_mask:0xf bank_mask:0xf
    v_fma_f32 v138, -v123, v123, v138
    v_cndmask_b32_dpp v154, v190, v186, vcc row_ror:4 row_mask:0xf bank_mask:0xf
    v_mul_f32 v139, v62, v123
    v_cndmask_b32_dpp v155, v191, v187, vcc row_ror:4 row_mask:0xf bank_mask:0xf
    v_cvt_pk_bf16_f32 v172, v138, v139
    v_cndmask_b32_dpp v160, v196, v192, vcc row_ror:4 row_mask:0xf bank_mask:0xf
    v_mul_f32 v140, v130, v130
    v_cndmask_b32_dpp v161, v197, v193, vcc row_ror:4 row_mask:0xf bank_mask:0xf
    v_add_f32 v63, v130, v130
    v_cndmask_b32_dpp v162, v198, v194, vcc row_ror:4 row_mask:0xf bank_mask:0xf
    v_fma_f32 v140, -v131, v131, v140
    v_cndmask_b32_dpp v163, v199, v195, vcc row_ror:4 row_mask:0xf bank_mask:0xf
    s_not_b64 vcc, vcc
    v_mul_f32 v141, v63, v131
    v_cndmask_b32_dpp v156, v184, v188, vcc row_ror:12 row_mask:0xf bank_mask:0xf
    v_cvt_pk_bf16_f32 v174, v140, v141
    v_cndmask_b32_dpp v157, v185, v189, vcc row_ror:12 row_mask:0xf bank_mask:0xf
    v_mul_f32 v142, v134, v74
    v_cndmask_b32_dpp v158, v186, v190, vcc row_ror:12 row_mask:0xf bank_mask:0xf
    v_mul_f32 v143, v134, v75
    v_cndmask_b32_dpp v159, v187, v191, vcc row_ror:12 row_mask:0xf bank_mask:0xf
    v_fmac_f32 v142, v135, v59
    v_cndmask_b32_dpp v164, v192, v196, vcc row_ror:12 row_mask:0xf bank_mask:0xf
    v_fmac_f32 v143, v135, v74
    v_cndmask_b32_dpp v165, v193, v197, vcc row_ror:12 row_mask:0xf bank_mask:0xf
    v_cvt_pk_bf16_f32 v169, v142, v143
    v_cndmask_b32_dpp v166, v194, v198, vcc row_ror:12 row_mask:0xf bank_mask:0xf
    v_mul_f32 v144, v136, v74
    v_cndmask_b32_dpp v167, v195, v199, vcc row_ror:12 row_mask:0xf bank_mask:0xf
    s_mov_b32 vcc_lo, 0x33333333
    s_mov_b32 vcc_hi, 0x33333333
    v_mul_f32 v145, v136, v75
    v_cndmask_b32_dpp v184, v154, v152, vcc quad_perm:[2,3,0,1] row_mask:0xf bank_mask:0xf
    v_fmac_f32 v144, v137, v59
    v_cndmask_b32_dpp v185, v155, v153, vcc quad_perm:[2,3,0,1] row_mask:0xf bank_mask:0xf
    v_fmac_f32 v145, v137, v74
    v_cndmask_b32_dpp v188, v158, v156, vcc quad_perm:[2,3,0,1] row_mask:0xf bank_mask:0xf
    v_cvt_pk_bf16_f32 v171, v144, v145
    v_cndmask_b32_dpp v189, v159, v157, vcc quad_perm:[2,3,0,1] row_mask:0xf bank_mask:0xf
    v_mul_f32 v146, v138, v74
    v_cndmask_b32_dpp v192, v162, v160, vcc quad_perm:[2,3,0,1] row_mask:0xf bank_mask:0xf
    v_mul_f32 v147, v138, v75
    v_cndmask_b32_dpp v193, v163, v161, vcc quad_perm:[2,3,0,1] row_mask:0xf bank_mask:0xf
    v_fmac_f32 v146, v139, v59
    v_cndmask_b32_dpp v196, v166, v164, vcc quad_perm:[2,3,0,1] row_mask:0xf bank_mask:0xf
    v_fmac_f32 v147, v139, v74
    v_cndmask_b32_dpp v197, v167, v165, vcc quad_perm:[2,3,0,1] row_mask:0xf bank_mask:0xf
    s_not_b64 vcc, vcc
    v_cvt_pk_bf16_f32 v173, v146, v147
    v_cndmask_b32_dpp v186, v152, v154, vcc quad_perm:[2,3,0,1] row_mask:0xf bank_mask:0xf
    v_mul_f32 v148, v140, v74
    s_cmp_ge_u32 s87, 4
    s_cbranch_scc1 S_wt9
    buffer_load_dword v3, v2, s[48:51], s85 offen
    s_add_u32 s85, s85, 131072
S_wt9:
    v_cndmask_b32_dpp v187, v153, v155, vcc quad_perm:[2,3,0,1] row_mask:0xf bank_mask:0xf
    v_mul_f32 v149, v140, v75
    v_cndmask_b32_dpp v190, v156, v158, vcc quad_perm:[2,3,0,1] row_mask:0xf bank_mask:0xf
    v_fmac_f32 v148, v141, v59
    v_cndmask_b32_dpp v191, v157, v159, vcc quad_perm:[2,3,0,1] row_mask:0xf bank_mask:0xf
    v_fmac_f32 v149, v141, v74
    v_cndmask_b32_dpp v194, v160, v162, vcc quad_perm:[2,3,0,1] row_mask:0xf bank_mask:0xf
    v_cvt_pk_bf16_f32 v175, v148, v149
    v_cndmask_b32_dpp v195, v161, v163, vcc quad_perm:[2,3,0,1] row_mask:0xf bank_mask:0xf
    v_mul_f32 v150, v134, v134
    v_cndmask_b32_dpp v198, v164, v166, vcc quad_perm:[2,3,0,1] row_mask:0xf bank_mask:0xf
    v_add_f32 v60, v134, v134
    v_cndmask_b32_dpp v199, v165, v167, vcc quad_perm:[2,3,0,1] row_mask:0xf bank_mask:0xf
    s_mov_b32 vcc_lo, 0x55555555
    s_mov_b32 vcc_hi, 0x55555555
    v_fma_f32 v150, -v135, v135, v150
    v_cndmask_b32_dpp v200, v185, v184, vcc quad_perm:[1,0,3,2] row_mask:0xf bank_mask:0xf
    v_mul_f32 v151, v60, v135
    v_cndmask_b32_dpp v202, v187, v186, vcc quad_perm:[1,0,3,2] row_mask:0xf bank_mask:0xf
    v_cvt_pk_bf16_f32 v176, v150, v151
    v_cndmask_b32_dpp v204, v189, v188, vcc quad_perm:[1,0,3,2] row_mask:0xf bank_mask:0xf
    v_lshlrev_b32 v16, 3, v0
    v_cndmask_b32_dpp v206, v191, v190, vcc quad_perm:[1,0,3,2] row_mask:0xf bank_mask:0xf
    v_sub_u32 v16, 2047, v16
    v_cndmask_b32_dpp v208, v193, v192, vcc quad_perm:[1,0,3,2] row_mask:0xf bank_mask:0xf
    v_cvt_f32_u32 v16, v16
    v_cndmask_b32_dpp v210, v195, v194, vcc quad_perm:[1,0,3,2] row_mask:0xf bank_mask:0xf
    v_add_f32 v76, 0x80000000, v16
    v_cndmask_b32_dpp v212, v197, v196, vcc quad_perm:[1,0,3,2] row_mask:0xf bank_mask:0xf
    v_add_f32 v77, 0xbf800000, v16
    v_cndmask_b32_dpp v214, v199, v198, vcc quad_perm:[1,0,3,2] row_mask:0xf bank_mask:0xf
    s_not_b64 vcc, vcc
    v_add_f32 v78, 0xc0000000, v16
    v_cndmask_b32_dpp v201, v184, v185, vcc quad_perm:[1,0,3,2] row_mask:0xf bank_mask:0xf
    v_add_f32 v79, 0xc0400000, v16
    v_cndmask_b32_dpp v203, v186, v187, vcc quad_perm:[1,0,3,2] row_mask:0xf bank_mask:0xf
    v_add_f32 v80, 0xc0800000, v16
    v_cndmask_b32_dpp v205, v188, v189, vcc quad_perm:[1,0,3,2] row_mask:0xf bank_mask:0xf
    v_mfma_f32_16x16x32_bf16 v[236:239], v[200:203], v[216:219], v[236:239]
    v_cndmask_b32_dpp v207, v190, v191, vcc quad_perm:[1,0,3,2] row_mask:0xf bank_mask:0xf
    v_add_f32 v81, 0xc0a00000, v16
    v_cndmask_b32_dpp v209, v192, v193, vcc quad_perm:[1,0,3,2] row_mask:0xf bank_mask:0xf
    v_mfma_f32_16x16x32_bf16 v[236:239], v[204:207], v[220:223], v[236:239]
    v_cndmask_b32_dpp v211, v194, v195, vcc quad_perm:[1,0,3,2] row_mask:0xf bank_mask:0xf
    v_mov_b32_dpp v193, v169 row_ror:8 row_mask:0xf bank_mask:0xf
    v_cndmask_b32_dpp v213, v196, v197, vcc quad_perm:[1,0,3,2] row_mask:0xf bank_mask:0xf
    v_mfma_f32_16x16x32_bf16 v[236:239], v[208:211], v[224:227], v[236:239]
    v_lshlrev_b32 v6, 4, v12
    s_lshr_b32 s38, s25, 5
    s_lshl_b32 s38, s38, 10
    s_add_u32 s38, s38, 16384
    v_add_u32 v6, s38, v6
    buffer_load_dwordx4 v[8:11], v6, s[56:59], 0 offen sc1
    v_cndmask_b32_dpp v215, v198, v199, vcc quad_perm:[1,0,3,2] row_mask:0xf bank_mask:0xf
    s_mov_b32 vcc_lo, 0xff00ff
    s_mov_b32 vcc_hi, 0xff00ff
    v_mfma_f32_16x16x32_bf16 v[236:239], v[212:215], v[228:231], v[236:239]
    v_cndmask_b32_dpp v184, v176, v168, vcc row_ror:8 row_mask:0xf bank_mask:0xf
    s_not_b64 vcc, vcc
    v_mov_b32_dpp v194, v170 row_ror:8 row_mask:0xf bank_mask:0xf
    v_cndmask_b32_dpp v192, v168, v176, vcc row_ror:8 row_mask:0xf bank_mask:0xf
    s_mov_b32 vcc_lo, 0xf0f0f0f
    s_mov_b32 vcc_hi, 0xf0f0f0f
    v_mov_b32_dpp v195, v171 row_ror:8 row_mask:0xf bank_mask:0xf
    v_cndmask_b32_dpp v168, v172, v184, vcc row_ror:4 row_mask:0xf bank_mask:0xf
    v_mov_b32_dpp v196, v172 row_ror:8 row_mask:0xf bank_mask:0xf
    v_cndmask_b32_dpp v176, v173, v169, vcc row_ror:4 row_mask:0xf bank_mask:0xf
    v_mov_b32_dpp v197, v173 row_ror:8 row_mask:0xf bank_mask:0xf
    s_cmp_ge_u32 s87, 4
    s_cbranch_scc1 S_wt10
    buffer_load_dword v3, v2, s[48:51], s85 offen
    s_add_u32 s85, s85, 131072
S_wt10:
    v_cndmask_b32_dpp v177, v174, v170, vcc row_ror:4 row_mask:0xf bank_mask:0xf
    v_mov_b32_dpp v198, v174 row_ror:8 row_mask:0xf bank_mask:0xf
    v_cndmask_b32_dpp v178, v175, v171, vcc row_ror:4 row_mask:0xf bank_mask:0xf
    v_mov_b32_dpp v199, v175 row_ror:8 row_mask:0xf bank_mask:0xf
    v_cndmask_b32_dpp v183, v196, v192, vcc row_ror:4 row_mask:0xf bank_mask:0xf
    v_add_f32 v82, 0xc0c00000, v16
    v_cndmask_b32_dpp v185, v197, v193, vcc row_ror:4 row_mask:0xf bank_mask:0xf
    v_add_f32 v83, 0xc0e00000, v16
    v_cndmask_b32_dpp v186, v198, v194, vcc row_ror:4 row_mask:0xf bank_mask:0xf
    v_add_f32 v84, 0xc1000000, v16
    v_cndmask_b32_dpp v187, v199, v195, vcc row_ror:4 row_mask:0xf bank_mask:0xf
    s_not_b64 vcc, vcc
    v_cvt_pk_bf16_f32 v85, v76, v77
    v_cndmask_b32_dpp v179, v184, v172, vcc row_ror:12 row_mask:0xf bank_mask:0xf
    v_cvt_pk_bf16_f32 v86, v78, v79
    v_cndmask_b32_dpp v180, v169, v173, vcc row_ror:12 row_mask:0xf bank_mask:0xf
    v_cvt_pk_bf16_f32 v87, v80, v81
    v_cndmask_b32_dpp v181, v170, v174, vcc row_ror:12 row_mask:0xf bank_mask:0xf
    v_cvt_pk_bf16_f32 v88, v82, v83
    v_cndmask_b32_dpp v182, v171, v175, vcc row_ror:12 row_mask:0xf bank_mask:0xf
    v_cvt_pk_bf16_f32 v89, v84, v84
    v_cndmask_b32_dpp v188, v192, v196, vcc row_ror:12 row_mask:0xf bank_mask:0xf
    v_lshlrev_b32 v76, 16, v85
    v_cndmask_b32_dpp v189, v193, v197, vcc row_ror:12 row_mask:0xf bank_mask:0xf
    v_and_b32 v77, 0xffff0000, v85
    v_cndmask_b32_dpp v190, v194, v198, vcc row_ror:12 row_mask:0xf bank_mask:0xf
    v_lshlrev_b32 v78, 16, v86
    v_cndmask_b32_dpp v191, v195, v199, vcc row_ror:12 row_mask:0xf bank_mask:0xf
    s_mov_b32 vcc_lo, 0x33333333
    s_mov_b32 vcc_hi, 0x33333333
    v_and_b32 v79, 0xffff0000, v86
    v_cndmask_b32_dpp v169, v177, v168, vcc quad_perm:[2,3,0,1] row_mask:0xf bank_mask:0xf
    v_lshlrev_b32 v80, 16, v87
    v_cndmask_b32_dpp v170, v178, v176, vcc quad_perm:[2,3,0,1] row_mask:0xf bank_mask:0xf
    v_and_b32 v81, 0xffff0000, v87
    v_cndmask_b32_dpp v173, v181, v179, vcc quad_perm:[2,3,0,1] row_mask:0xf bank_mask:0xf
    v_lshlrev_b32 v82, 16, v88
    v_cndmask_b32_dpp v174, v182, v180, vcc quad_perm:[2,3,0,1] row_mask:0xf bank_mask:0xf
    v_and_b32 v83, 0xffff0000, v88
    v_cndmask_b32_dpp v192, v186, v183, vcc quad_perm:[2,3,0,1] row_mask:0xf bank_mask:0xf
    v_lshlrev_b32 v84, 16, v89
    v_cndmask_b32_dpp v193, v187, v185, vcc quad_perm:[2,3,0,1] row_mask:0xf bank_mask:0xf
    v_frexp_exp_i32_f32 v85, v76
    v_cndmask_b32_dpp v196, v190, v188, vcc quad_perm:[2,3,0,1] row_mask:0xf bank_mask:0xf
    v_cvt_u32_f32 v94, v76
    v_cndmask_b32_dpp v197, v191, v189, vcc quad_perm:[2,3,0,1] row_mask:0xf bank_mask:0xf
    s_not_b64 vcc, vcc
    v_frexp_exp_i32_f32 v86, v77
    v_cndmask_b32_dpp v171, v168, v177, vcc quad_perm:[2,3,0,1] row_mask:0xf bank_mask:0xf
    v_cvt_u32_f32 v95, v77
    v_cndmask_b32_dpp v172, v176, v178, vcc quad_perm:[2,3,0,1] row_mask:0xf bank_mask:0xf
    v_frexp_exp_i32_f32 v87, v78
    v_cndmask_b32_dpp v175, v179, v181, vcc quad_perm:[2,3,0,1] row_mask:0xf bank_mask:0xf
    v_cvt_u32_f32 v96, v78
    v_cndmask_b32_dpp v184, v180, v182, vcc quad_perm:[2,3,0,1] row_mask:0xf bank_mask:0xf
    v_frexp_exp_i32_f32 v88, v79
    v_cndmask_b32_dpp v194, v183, v186, vcc quad_perm:[2,3,0,1] row_mask:0xf bank_mask:0xf
    v_cvt_u32_f32 v97, v79
    v_cndmask_b32_dpp v195, v185, v187, vcc quad_perm:[2,3,0,1] row_mask:0xf bank_mask:0xf
    v_frexp_exp_i32_f32 v89, v80
    v_cndmask_b32_dpp v198, v188, v190, vcc quad_perm:[2,3,0,1] row_mask:0xf bank_mask:0xf
    v_cvt_u32_f32 v98, v80
    v_cndmask_b32_dpp v199, v189, v191, vcc quad_perm:[2,3,0,1] row_mask:0xf bank_mask:0xf
    s_cmp_ge_u32 s87, 4
    s_cbranch_scc1 S_wt11
    buffer_load_dword v3, v2, s[48:51], s85 offen
    s_add_u32 s85, s85, 131072
S_wt11:
    s_mov_b32 vcc_lo, 0x55555555
    s_mov_b32 vcc_hi, 0x55555555
    v_frexp_exp_i32_f32 v90, v81
    v_cndmask_b32_dpp v200, v170, v169, vcc quad_perm:[1,0,3,2] row_mask:0xf bank_mask:0xf
    v_cvt_u32_f32 v99, v81
    v_cndmask_b32_dpp v202, v172, v171, vcc quad_perm:[1,0,3,2] row_mask:0xf bank_mask:0xf
    v_frexp_exp_i32_f32 v91, v82
    v_cndmask_b32_dpp v204, v174, v173, vcc quad_perm:[1,0,3,2] row_mask:0xf bank_mask:0xf
    v_cvt_u32_f32 v100, v82
    v_cndmask_b32_dpp v206, v184, v175, vcc quad_perm:[1,0,3,2] row_mask:0xf bank_mask:0xf
    v_frexp_exp_i32_f32 v92, v83
    v_cndmask_b32_dpp v208, v193, v192, vcc quad_perm:[1,0,3,2] row_mask:0xf bank_mask:0xf
    v_cvt_u32_f32 v101, v83
    v_cndmask_b32_dpp v210, v195, v194, vcc quad_perm:[1,0,3,2] row_mask:0xf bank_mask:0xf
    v_frexp_exp_i32_f32 v93, v84
    v_cndmask_b32_dpp v212, v197, v196, vcc quad_perm:[1,0,3,2] row_mask:0xf bank_mask:0xf
    v_cvt_u32_f32 v25, v84
    v_cndmask_b32_dpp v214, v199, v198, vcc quad_perm:[1,0,3,2] row_mask:0xf bank_mask:0xf
    s_not_b64 vcc, vcc
    v_subrev_u32 v85, 8, v85
    v_cndmask_b32_dpp v201, v169, v170, vcc quad_perm:[1,0,3,2] row_mask:0xf bank_mask:0xf
    v_lshrrev_b32 v76, 7, v94
    v_cndmask_b32_dpp v203, v171, v172, vcc quad_perm:[1,0,3,2] row_mask:0xf bank_mask:0xf
    v_and_b32 v16, 7, v94
    v_cndmask_b32_dpp v205, v173, v174, vcc quad_perm:[1,0,3,2] row_mask:0xf bank_mask:0xf
    v_mfma_f32_16x16x32_bf16 v[240:243], v[200:203], v[216:219], v[240:243]
    v_cndmask_b32_dpp v207, v175, v184, vcc quad_perm:[1,0,3,2] row_mask:0xf bank_mask:0xf
    v_subrev_u32 v86, 8, v86
    v_cndmask_b32_dpp v209, v192, v193, vcc quad_perm:[1,0,3,2] row_mask:0xf bank_mask:0xf
    v_mfma_f32_16x16x32_bf16 v[240:243], v[204:207], v[220:223], v[240:243]
    v_cndmask_b32_dpp v211, v194, v195, vcc quad_perm:[1,0,3,2] row_mask:0xf bank_mask:0xf
    v_lshrrev_b32 v77, 7, v95
    v_cndmask_b32_dpp v213, v196, v197, vcc quad_perm:[1,0,3,2] row_mask:0xf bank_mask:0xf
    v_mfma_f32_16x16x32_bf16 v[240:243], v[208:211], v[224:227], v[240:243]
    v_cndmask_b32_dpp v215, v198, v199, vcc quad_perm:[1,0,3,2] row_mask:0xf bank_mask:0xf
    v_and_b32 v17, 7, v95
    v_subrev_u32 v87, 8, v87
    v_mfma_f32_16x16x32_bf16 v[240:243], v[212:215], v[228:231], v[240:243]
    v_lshrrev_b32 v78, 7, v96
    v_and_b32 v18, 7, v96
    v_subrev_u32 v88, 8, v88
    v_lshrrev_b32 v79, 7, v97
    v_and_b32 v19, 7, v97
    v_subrev_u32 v89, 8, v89
    v_lshrrev_b32 v80, 7, v98
    v_and_b32 v20, 7, v98
    v_subrev_u32 v90, 8, v90
    v_lshrrev_b32 v81, 7, v99
    v_and_b32 v21, 7, v99
    v_subrev_u32 v91, 8, v91
    v_lshrrev_b32 v82, 7, v100
    v_and_b32 v22, 7, v100
    v_subrev_u32 v92, 8, v92
    v_lshrrev_b32 v83, 7, v101
    v_and_b32 v23, 7, v101
    v_subrev_u32 v93, 8, v93
    v_lshrrev_b32 v84, 7, v25
    v_and_b32 v24, 7, v25
    v_max_i32 v85, 0, v85
    v_lshl_or_b32 v76, v76, 3, v16
    v_bfe_u32 v94, v94, 3, 4
    v_max_i32 v86, 0, v86
    s_cmp_ge_u32 s87, 4
    s_cbranch_scc1 S_wt12
    buffer_load_dword v3, v2, s[48:51], s85 offen
    s_add_u32 s85, s85, 131072
S_wt12:
    v_lshl_or_b32 v77, v77, 3, v17
    v_bfe_u32 v95, v95, 3, 4
    v_max_i32 v87, 0, v87
    v_lshl_or_b32 v78, v78, 3, v18
    v_bfe_u32 v96, v96, 3, 4
    v_max_i32 v88, 0, v88
    v_lshl_or_b32 v79, v79, 3, v19
    v_bfe_u32 v97, v97, 3, 4
    v_max_i32 v89, 0, v89
    v_lshl_or_b32 v80, v80, 3, v20
    v_bfe_u32 v98, v98, 3, 4
    v_max_i32 v90, 0, v90
    v_lshl_or_b32 v81, v81, 3, v21
    v_bfe_u32 v99, v99, 3, 4
    v_max_i32 v91, 0, v91
    v_lshl_or_b32 v82, v82, 3, v22
    v_bfe_u32 v100, v100, 3, 4
    v_max_i32 v92, 0, v92
    v_lshl_or_b32 v83, v83, 3, v23
    v_bfe_u32 v101, v101, 3, 4
    v_max_i32 v93, 0, v93
    v_lshl_or_b32 v84, v84, 3, v24
    v_bfe_u32 v25, v25, 3, 4
    v_lshrrev_b32 v76, v85, v76
    v_lshlrev_b32 v94, 2, v94
    v_lshrrev_b32 v77, v86, v77
    v_lshlrev_b32 v95, 2, v95
    s_mov_b64 s[28:29], vcc
    s_waitcnt vmcnt(0)
    s_mov_b32 s99, 65536
    s_branch SU_pc
SU_pl:
    buffer_load_dwordx4 v[8:11], v6, s[56:59], 0 offen sc1
    s_waitcnt vmcnt(0)
SU_pc:
    v_cmp_ne_u64 vcc, s[96:97], v[8:9]
    v_cmp_ne_u64 s[100:101], s[96:97], v[10:11]
    s_sub_u32 s99, s99, 1
    s_cbranch_scc1 SU_pd
    s_or_b64 vcc, vcc, s[100:101]
    s_cbranch_scc0 SU_pd
    s_sleep 4
    s_branch SU_pl
SU_pd:
    s_barrier
    v_lshlrev_b32 v6, 6, v12
    s_lshr_b32 s38, s25, 1
    s_lshl_b32 s38, s38, 14
    s_and_b32 s39, s25, 1
    s_lshl_b32 s39, s39, 5
    s_add_u32 s38, s38, s39
    s_lshl_b32 s39, s24, 12
    s_add_u32 s38, s38, s39
    s_lshl_b32 s39, s24, 10
    s_add_u32 m0, s39, 63296
    s_mov_b64 vcc, s[28:29]
    buffer_load_dwordx4 v6, s[12:15], s38 offen lds
    s_add_u32 m0, s39, 67904
    s_add_u32 s38, s38, 16
    buffer_load_dwordx4 v6, s[12:15], s38 offen lds
    v_lshrrev_b32 v78, v87, v78
    v_lshlrev_b32 v96, 2, v96
    v_lshrrev_b32 v79, v88, v79
    v_lshlrev_b32 v97, 2, v97
    v_lshrrev_b32 v80, v89, v80
    v_lshlrev_b32 v98, 2, v98
    v_lshrrev_b32 v81, v90, v81
    v_lshlrev_b32 v99, 2, v99
    v_lshrrev_b32 v82, v91, v82
    v_lshlrev_b32 v100, 2, v100
    v_lshrrev_b32 v83, v92, v83
    v_lshlrev_b32 v101, 2, v101
    v_lshrrev_b32 v84, v93, v84
    v_lshlrev_b32 v25, 2, v25
    v_lshl_add_u32 v76, v85, 3, v76
    v_add_u32 v94, 49664, v94
    v_lshl_add_u32 v77, v86, 3, v77
    v_add_u32 v95, 49664, v95
    v_lshl_add_u32 v78, v87, 3, v78
    v_add_u32 v96, 49664, v96
    v_lshl_add_u32 v79, v88, 3, v79
    v_add_u32 v97, 49664, v97
    v_lshl_add_u32 v80, v89, 3, v80
    v_add_u32 v98, 49664, v98
    v_lshl_add_u32 v81, v90, 3, v81
    v_add_u32 v99, 49664, v99
    v_lshl_add_u32 v82, v91, 3, v82
    v_add_u32 v100, 49664, v100
    v_lshl_add_u32 v83, v92, 3, v83
    v_add_u32 v101, 49664, v101
    v_lshl_add_u32 v84, v93, 3, v84
    v_add_u32 v25, 49664, v25
    v_mov_b32 v64, 80
    v_mad_u32_u24 v16, v76, v64, v94
    v_mad_u32_u24 v17, v77, v64, v95
    v_mad_u32_u24 v18, v78, v64, v96
    v_mad_u32_u24 v19, v79, v64, v97
    v_mad_u32_u24 v20, v80, v64, v98
    v_mad_u32_u24 v21, v81, v64, v99
    v_mad_u32_u24 v22, v82, v64, v100
    v_mad_u32_u24 v23, v83, v64, v101
    v_mad_u32_u24 v24, v84, v64, v25
    v_mov_b32 v7, 49728
    v_cmp_eq_u32 vcc, 255, v0
    v_and_b32 v6, 15, v12
    s_lshr_b32 s32, s24, 1
    v_cndmask_b32 v24, v24, v7, vcc
    v_lshrrev_b32 v7, 4, v12
    s_and_b32 s27, s24, 1
    v_not_b32 v8, v6
    v_and_b32 v8, 3, v8
    ds_write_b32 v28, v232 offset:0
    ds_write_b32 v28, v233 offset:80
    ds_write_b32 v28, v234 offset:160
    ds_write_b32 v28, v235 offset:240
    ds_write_b32 v28, v236 offset:1280
    ds_write_b32 v28, v237 offset:1360
    ds_write_b32 v28, v238 offset:1440
    ds_write_b32 v28, v239 offset:1520
    s_mov_b32 exec_hi, 0xffff
    ds_write_b32 v28, v240 offset:2560
    s_mov_b32 exec_hi, 0
    ds_write_b32 v28, v241 offset:2640
    ds_write_b32 v28, v242 offset:2720
    ds_write_b32 v28, v243 offset:2800
    s_mov_b64 exec, -1
    v_mul_u32_u24 v8, 4160, v8
    v_and_b32 v9, 12, v6
    v_lshlrev_b32 v9, 1, v9
    v_sub_u32 v8, v8, v9
    v_lshl_add_u32 v8, v7, 4, v8
    s_mul_i32 s38, s32, 16640
    s_lshl_b32 s39, s27, 6
    s_sub_u32 s38, s38, s39
    s_add_u32 s38, s38, 88
    v_add_u32 v1, s38, v8
    v_lshlrev_b32 v8, 5, v6
    v_lshl_add_u32 v9, v7, 4, v8
    s_mul_i32 s38, s32, 4608
    s_add_u32 s38, s38, 63296
    s_sub_u32 s39, s38, s39
    s_sub_u32 s39, s39, 416
    v_add_u32 v2, s39, v9
    v_lshl_add_u32 v3, v7, 3, v8
    v_add_u32 v4, s38, v3
    v_and_b32 v3, 2, v7
    v_lshl_add_u32 v3, v3, 3, v8
    v_and_b32 v5, 1, v7
    v_lshl_add_u32 v3, v5, 10, v3
    s_waitcnt lgkmcnt(0)
    s_barrier
    ds_read_b32 v100, v16 offset:0
    ds_read_b32 v110, v16 offset:3280
    ds_read_b32 v101, v17 offset:0
    ds_read_b32 v111, v17 offset:3280
    ds_read_b32 v102, v18 offset:0
    ds_read_b32 v112, v18 offset:3280
    ds_read_b32 v103, v19 offset:0
    ds_read_b32 v113, v19 offset:3280
    ds_read_b32 v104, v20 offset:0
    ds_read_b32 v114, v20 offset:3280
    ds_read_b32 v105, v21 offset:0
    ds_read_b32 v115, v21 offset:3280
    ds_read_b32 v106, v22 offset:0
    ds_read_b32 v116, v22 offset:3280
    ds_read_b32 v107, v23 offset:0
    ds_read_b32 v117, v23 offset:3280
    ds_read_b32 v108, v24 offset:0
    ds_read_b32 v118, v24 offset:3280
    ds_read_b32 v120, v16 offset:6560
    ds_read_b32 v130, v16 offset:9840
    ds_read_b32 v121, v17 offset:6560
    ds_read_b32 v131, v17 offset:9840
    ds_read_b32 v122, v18 offset:6560
    ds_read_b32 v132, v18 offset:9840
    ds_read_b32 v123, v19 offset:6560
    ds_read_b32 v133, v19 offset:9840
    ds_read_b32 v124, v20 offset:6560
    ds_read_b32 v134, v20 offset:9840
    ds_read_b32 v125, v21 offset:6560
    ds_read_b32 v135, v21 offset:9840
    ds_read_b32 v126, v22 offset:6560
    ds_read_b32 v136, v22 offset:9840
    ds_read_b32 v127, v23 offset:6560
    ds_read_b32 v137, v23 offset:9840
    ds_read_b32 v128, v24 offset:6560
    ds_read_b32 v138, v24 offset:9840
    v_lshlrev_b32 v5, 4, v12
    s_lshl_b32 s38, s24, 12
    s_add_u32 s38, s38, 33280
    v_add_u32 v14, s38, v5
    s_xor_b32 s38, s24, 1
    s_lshl_b32 s38, s38, 12
    s_add_u32 s38, s38, 33280
    v_add_u32 v15, s38, v5
    s_lshl_b32 s35, s37, 16
    s_and_b32 s38, s37, 0xffff0000
    s_cmp_eq_u32 s32, 1
    s_cselect_b32 s35, s38, s35
    s_lshl_b32 s33, s25, 1
    s_add_u32 s33, s33, s32
    s_lshl_b32 s33, s33, 12
    v_lshlrev_b32 v6, 4, v0
    v_add_u32 v7, 8316, v6
    v_add_u32 v8, 12476, v6
    v_add_u32 v9, 24956, v6
    v_add_u32 v10, 29116, v6
    s_waitcnt lgkmcnt(15)
    v_add_f32 v100, v100, v110
    v_add_f32 v101, v101, v111
    v_add_f32 v102, v102, v112
    v_add_f32 v103, v103, v113
    v_add_f32 v104, v104, v114
    v_add_f32 v105, v105, v115
    v_add_f32 v106, v106, v116
    v_add_f32 v107, v107, v117
    v_add_f32 v108, v108, v118
    v_cvt_pk_bf16_f32 v64, v100, v101
    v_cvt_pk_bf16_f32 v72, v101, v102
    v_cvt_pk_bf16_f32 v65, v102, v103
    v_cvt_pk_bf16_f32 v73, v103, v104
    v_cvt_pk_bf16_f32 v66, v104, v105
    v_cvt_pk_bf16_f32 v74, v105, v106
    v_cvt_pk_bf16_f32 v67, v106, v107
    v_cvt_pk_bf16_f32 v75, v107, v108
    ds_write_b128 v6, v[64:67] offset:0
    ds_write_b128 v6, v[72:75] offset:4160
    ds_write2_b32 v7, v64, v65 offset0:0 offset1:1
    ds_write2_b32 v7, v66, v67 offset0:2 offset1:3
    ds_write2_b32 v8, v72, v73 offset0:0 offset1:1
    ds_write2_b32 v8, v74, v75 offset0:2 offset1:3
    s_waitcnt lgkmcnt(6)
    v_add_f32 v120, v120, v130
    v_add_f32 v121, v121, v131
    v_add_f32 v122, v122, v132
    v_add_f32 v123, v123, v133
    v_add_f32 v124, v124, v134
    v_add_f32 v125, v125, v135
    v_add_f32 v126, v126, v136
    v_add_f32 v127, v127, v137
    v_add_f32 v128, v128, v138
    v_cvt_pk_bf16_f32 v80, v120, v121
    v_cvt_pk_bf16_f32 v88, v121, v122
    v_cvt_pk_bf16_f32 v81, v122, v123
    v_cvt_pk_bf16_f32 v89, v123, v124
    v_cvt_pk_bf16_f32 v82, v124, v125
    v_cvt_pk_bf16_f32 v90, v125, v126
    v_cvt_pk_bf16_f32 v83, v126, v127
    v_cvt_pk_bf16_f32 v91, v127, v128
    ds_write_b128 v6, v[80:83] offset:16640
    ds_write_b128 v6, v[88:91] offset:20800
    ds_write2_b32 v9, v80, v81 offset0:0 offset1:1
    ds_write2_b32 v9, v82, v83 offset0:2 offset1:3
    ds_write2_b32 v10, v88, v89 offset0:0 offset1:1
    ds_write2_b32 v10, v90, v91 offset0:2 offset1:3
    s_cmp_lg_u32 s24, 0
    s_cbranch_scc1 S_nozero
    s_mov_b64 exec, 3
    v_mov_b32 v96, 0
    v_mov_b32 v97, 0
    v_mov_b32 v98, 0
    v_mov_b32 v99, 0
    v_add_u32 v6, 4096, v6
    v_add_u32 v7, 4096, v7
    v_add_u32 v8, 4096, v8
    v_add_u32 v9, 4096, v9
    v_add_u32 v10, 4096, v10
    ds_write_b128 v6, v[96:99] offset:0
    ds_write_b128 v6, v[96:99] offset:4160
    ds_write2_b32 v7, v96, v97 offset0:0 offset1:1
    ds_write2_b32 v7, v98, v99 offset0:2 offset1:3
    ds_write2_b32 v8, v96, v97 offset0:0 offset1:1
    ds_write2_b32 v8, v98, v99 offset0:2 offset1:3
    ds_write_b128 v6, v[96:99] offset:16640
    ds_write_b128 v6, v[96:99] offset:20800
    ds_write2_b32 v9, v96, v97 offset0:0 offset1:1
    ds_write2_b32 v9, v98, v99 offset0:2 offset1:3
    ds_write2_b32 v10, v96, v97 offset0:0 offset1:1
    ds_write2_b32 v10, v98, v99 offset0:2 offset1:3
    s_mov_b64 exec, -1
S_nozero:
    s_waitcnt vmcnt(0) lgkmcnt(0)
    s_barrier
    ds_read_b64 v[48:49], v1 offset:3968
    ds_read_b64 v[50:51], v1 offset:3976
    ds_read_b128 v[64:67], v2 offset:384
    ds_read_b128 v[68:71], v2 offset:896
    ds_read_b128 v[72:75], v2 offset:1408
    ds_read_b128 v[76:79], v2 offset:1920
    ds_read_b128 v[80:83], v2 offset:2432
    ds_read_b128 v[84:87], v2 offset:2944
    ds_read_b128 v[88:91], v2 offset:3456
    ds_read_b128 v[92:95], v2 offset:3968
    ds_read_b64 v[52:53], v1 offset:3456
    ds_read_b64 v[54:55], v1 offset:3464
    ds_read_b64 v[56:57], v1 offset:2944
    ds_read_b64 v[58:59], v1 offset:2952
    s_waitcnt lgkmcnt(11)
    v_mfma_f32_16x16x32_bf16 v[16:19], v[48:51], v[64:67], 0
    ds_read_b64 v[60:61], v1 offset:2432
    ds_read_b64 v[62:63], v1 offset:2440
    ds_read_b128 v[96:99], v2 offset:256
    ds_read_b128 v[100:103], v2 offset:768
    s_waitcnt lgkmcnt(14)
    v_mfma_f32_16x16x32_bf16 v[20:23], v[48:51], v[68:71], 0
    s_waitcnt lgkmcnt(13)
    v_mfma_f32_16x16x32_bf16 v[24:27], v[48:51], v[72:75], 0
    s_waitcnt lgkmcnt(12)
    v_mfma_f32_16x16x32_bf16 v[28:31], v[48:51], v[76:79], 0
    s_waitcnt lgkmcnt(11)
    v_mfma_f32_16x16x32_bf16 v[32:35], v[48:51], v[80:83], 0
    s_waitcnt lgkmcnt(10)
    v_mfma_f32_16x16x32_bf16 v[36:39], v[48:51], v[84:87], 0
    s_waitcnt lgkmcnt(9)
    v_mfma_f32_16x16x32_bf16 v[40:43], v[48:51], v[88:91], 0
    s_waitcnt lgkmcnt(8)
    v_mfma_f32_16x16x32_bf16 v[44:47], v[48:51], v[92:95], 0
    s_waitcnt lgkmcnt(6)
    v_mfma_f32_16x16x32_bf16 v[20:23], v[52:55], v[64:67], v[20:23]
    ds_read_b64 v[48:49], v1 offset:1920
    ds_read_b64 v[50:51], v1 offset:1928
    ds_read_b128 v[104:107], v2 offset:1280
    ds_read_b128 v[108:111], v2 offset:1792
    v_mfma_f32_16x16x32_bf16 v[24:27], v[52:55], v[68:71], v[24:27]
    v_mfma_f32_16x16x32_bf16 v[28:31], v[52:55], v[72:75], v[28:31]
    v_mfma_f32_16x16x32_bf16 v[32:35], v[52:55], v[76:79], v[32:35]
    v_mfma_f32_16x16x32_bf16 v[36:39], v[52:55], v[80:83], v[36:39]
    v_mfma_f32_16x16x32_bf16 v[40:43], v[52:55], v[84:87], v[40:43]
    v_mfma_f32_16x16x32_bf16 v[44:47], v[52:55], v[88:91], v[44:47]
    s_waitcnt lgkmcnt(8)
    v_mfma_f32_16x16x32_bf16 v[24:27], v[56:59], v[64:67], v[24:27]
    ds_read_b64 v[52:53], v1 offset:1408
    ds_read_b64 v[54:55], v1 offset:1416
    ds_read_b128 v[112:115], v2 offset:2304
    ds_read_b128 v[116:119], v2 offset:2816
    v_mfma_f32_16x16x32_bf16 v[28:31], v[56:59], v[68:71], v[28:31]
    v_mfma_f32_16x16x32_bf16 v[32:35], v[56:59], v[72:75], v[32:35]
    v_mfma_f32_16x16x32_bf16 v[36:39], v[56:59], v[76:79], v[36:39]
    v_mfma_f32_16x16x32_bf16 v[40:43], v[56:59], v[80:83], v[40:43]
    v_mfma_f32_16x16x32_bf16 v[44:47], v[56:59], v[84:87], v[44:47]
    s_waitcnt lgkmcnt(10)
    v_mfma_f32_16x16x32_bf16 v[28:31], v[60:63], v[64:67], v[28:31]
    ds_read_b64 v[56:57], v1 offset:896
    ds_read_b64 v[58:59], v1 offset:904
    ds_read_b128 v[120:123], v2 offset:3328
    ds_read_b128 v[124:127], v2 offset:3840
    v_mfma_f32_16x16x32_bf16 v[32:35], v[60:63], v[68:71], v[32:35]
    v_mfma_f32_16x16x32_bf16 v[36:39], v[60:63], v[72:75], v[36:39]
    v_mfma_f32_16x16x32_bf16 v[40:43], v[60:63], v[76:79], v[40:43]
    v_mfma_f32_16x16x32_bf16 v[44:47], v[60:63], v[80:83], v[44:47]
    s_waitcnt lgkmcnt(10)
    v_mfma_f32_16x16x32_bf16 v[32:35], v[48:51], v[64:67], v[32:35]
    ds_read_b64 v[60:61], v1 offset:384
    ds_read_b64 v[62:63], v1 offset:392
    v_mfma_f32_16x16x32_bf16 v[36:39], v[48:51], v[68:71], v[36:39]
    v_mfma_f32_16x16x32_bf16 v[40:43], v[48:51], v[72:75], v[40:43]
    v_mfma_f32_16x16x32_bf16 v[44:47], v[48:51], v[76:79], v[44:47]
    s_waitcnt lgkmcnt(8)
    v_mfma_f32_16x16x32_bf16 v[36:39], v[52:55], v[64:67], v[36:39]
    ds_read_b64 v[48:49], v1 offset:3840
    ds_read_b64 v[50:51], v1 offset:3848
    v_mfma_f32_16x16x32_bf16 v[40:43], v[52:55], v[68:71], v[40:43]
    v_mfma_f32_16x16x32_bf16 v[44:47], v[52:55], v[72:75], v[44:47]
    s_waitcnt lgkmcnt(6)
    v_mfma_f32_16x16x32_bf16 v[40:43], v[56:59], v[64:67], v[40:43]
    ds_read_b64 v[52:53], v1 offset:3328
    ds_read_b64 v[54:55], v1 offset:3336
    v_mfma_f32_16x16x32_bf16 v[44:47], v[56:59], v[68:71], v[44:47]
    s_waitcnt lgkmcnt(4)
    v_mfma_f32_16x16x32_bf16 v[44:47], v[60:63], v[64:67], v[44:47]
    ds_read_b64 v[56:57], v1 offset:2816
    ds_read_b64 v[58:59], v1 offset:2824
    s_waitcnt lgkmcnt(4)
    v_mfma_f32_16x16x32_bf16 v[16:19], v[48:51], v[96:99], v[16:19]
    ds_read_b64 v[60:61], v1 offset:2304
    ds_read_b64 v[62:63], v1 offset:2312
    ds_read_b128 v[64:67], v2 offset:128
    ds_read_b128 v[68:71], v2 offset:640
    v_mfma_f32_16x16x32_bf16 v[20:23], v[48:51], v[100:103], v[20:23]
    v_mfma_f32_16x16x32_bf16 v[24:27], v[48:51], v[104:107], v[24:27]
    v_mfma_f32_16x16x32_bf16 v[28:31], v[48:51], v[108:111], v[28:31]
    v_mfma_f32_16x16x32_bf16 v[32:35], v[48:51], v[112:115], v[32:35]
    v_mfma_f32_16x16x32_bf16 v[36:39], v[48:51], v[116:119], v[36:39]
    v_mfma_f32_16x16x32_bf16 v[40:43], v[48:51], v[120:123], v[40:43]
    v_mfma_f32_16x16x32_bf16 v[44:47], v[48:51], v[124:127], v[44:47]
    s_waitcnt lgkmcnt(6)
    v_mfma_f32_16x16x32_bf16 v[20:23], v[52:55], v[96:99], v[20:23]
    ds_read_b64 v[48:49], v1 offset:1792
    ds_read_b64 v[50:51], v1 offset:1800
    ds_read_b128 v[72:75], v2 offset:1152
    ds_read_b128 v[76:79], v2 offset:1664
    v_mfma_f32_16x16x32_bf16 v[24:27], v[52:55], v[100:103], v[24:27]
    v_mfma_f32_16x16x32_bf16 v[28:31], v[52:55], v[104:107], v[28:31]
    v_mfma_f32_16x16x32_bf16 v[32:35], v[52:55], v[108:111], v[32:35]
    v_mfma_f32_16x16x32_bf16 v[36:39], v[52:55], v[112:115], v[36:39]
    v_mfma_f32_16x16x32_bf16 v[40:43], v[52:55], v[116:119], v[40:43]
    v_mfma_f32_16x16x32_bf16 v[44:47], v[52:55], v[120:123], v[44:47]
    s_waitcnt lgkmcnt(8)
    v_mfma_f32_16x16x32_bf16 v[24:27], v[56:59], v[96:99], v[24:27]
    ds_read_b64 v[52:53], v1 offset:1280
    ds_read_b64 v[54:55], v1 offset:1288
    ds_read_b128 v[80:83], v2 offset:2176
    ds_read_b128 v[84:87], v2 offset:2688
    v_mfma_f32_16x16x32_bf16 v[28:31], v[56:59], v[100:103], v[28:31]
    v_mfma_f32_16x16x32_bf16 v[32:35], v[56:59], v[104:107], v[32:35]
    v_mfma_f32_16x16x32_bf16 v[36:39], v[56:59], v[108:111], v[36:39]
    v_mfma_f32_16x16x32_bf16 v[40:43], v[56:59], v[112:115], v[40:43]
    v_mfma_f32_16x16x32_bf16 v[44:47], v[56:59], v[116:119], v[44:47]
    s_waitcnt lgkmcnt(10)
    v_mfma_f32_16x16x32_bf16 v[28:31], v[60:63], v[96:99], v[28:31]
    ds_read_b64 v[56:57], v1 offset:768
    ds_read_b64 v[58:59], v1 offset:776
    ds_read_b128 v[88:91], v2 offset:3200
    ds_read_b128 v[92:95], v2 offset:3712
    v_mfma_f32_16x16x32_bf16 v[32:35], v[60:63], v[100:103], v[32:35]
    v_mfma_f32_16x16x32_bf16 v[36:39], v[60:63], v[104:107], v[36:39]
    v_mfma_f32_16x16x32_bf16 v[40:43], v[60:63], v[108:111], v[40:43]
    v_mfma_f32_16x16x32_bf16 v[44:47], v[60:63], v[112:115], v[44:47]
    s_waitcnt lgkmcnt(10)
    v_mfma_f32_16x16x32_bf16 v[32:35], v[48:51], v[96:99], v[32:35]
    ds_read_b64 v[60:61], v1 offset:256
    ds_read_b64 v[62:63], v1 offset:264
    v_mfma_f32_16x16x32_bf16 v[36:39], v[48:51], v[100:103], v[36:39]
    v_mfma_f32_16x16x32_bf16 v[40:43], v[48:51], v[104:107], v[40:43]
    v_mfma_f32_16x16x32_bf16 v[44:47], v[48:51], v[108:111], v[44:47]
    s_waitcnt lgkmcnt(8)
    v_mfma_f32_16x16x32_bf16 v[36:39], v[52:55], v[96:99], v[36:39]
    ds_read_b64 v[48:49], v1 offset:3712
    ds_read_b64 v[50:51], v1 offset:3720
    v_mfma_f32_16x16x32_bf16 v[40:43], v[52:55], v[100:103], v[40:43]
    v_mfma_f32_16x16x32_bf16 v[44:47], v[52:55], v[104:107], v[44:47]
    s_waitcnt lgkmcnt(6)
    v_mfma_f32_16x16x32_bf16 v[40:43], v[56:59], v[96:99], v[40:43]
    ds_read_b64 v[52:53], v1 offset:3200
    ds_read_b64 v[54:55], v1 offset:3208
    v_mfma_f32_16x16x32_bf16 v[44:47], v[56:59], v[100:103], v[44:47]
    s_waitcnt lgkmcnt(4)
    v_mfma_f32_16x16x32_bf16 v[44:47], v[60:63], v[96:99], v[44:47]
    ds_read_b64 v[56:57], v1 offset:2688
    ds_read_b64 v[58:59], v1 offset:2696
    s_waitcnt lgkmcnt(4)
    v_mfma_f32_16x16x32_bf16 v[16:19], v[48:51], v[64:67], v[16:19]
    ds_read_b64 v[60:61], v1 offset:2176
    ds_read_b64 v[62:63], v1 offset:2184
    ds_read_b128 v[96:99], v2 offset:0
    ds_read_b128 v[100:103], v2 offset:512
    v_mfma_f32_16x16x32_bf16 v[20:23], v[48:51], v[68:71], v[20:23]
    v_mfma_f32_16x16x32_bf16 v[24:27], v[48:51], v[72:75], v[24:27]
    v_mfma_f32_16x16x32_bf16 v[28:31], v[48:51], v[76:79], v[28:31]
    v_mfma_f32_16x16x32_bf16 v[32:35], v[48:51], v[80:83], v[32:35]
    v_mfma_f32_16x16x32_bf16 v[36:39], v[48:51], v[84:87], v[36:39]
    v_mfma_f32_16x16x32_bf16 v[40:43], v[48:51], v[88:91], v[40:43]
    v_mfma_f32_16x16x32_bf16 v[44:47], v[48:51], v[92:95], v[44:47]
    s_waitcnt lgkmcnt(6)
    v_mfma_f32_16x16x32_bf16 v[20:23], v[52:55], v[64:67], v[20:23]
    ds_read_b64 v[48:49], v1 offset:1664
    ds_read_b64 v[50:51], v1 offset:1672
    ds_read_b128 v[104:107], v2 offset:1024
    ds_read_b128 v[108:111], v2 offset:1536
    v_mfma_f32_16x16x32_bf16 v[24:27], v[52:55], v[68:71], v[24:27]
    v_mfma_f32_16x16x32_bf16 v[28:31], v[52:55], v[72:75], v[28:31]
    v_mfma_f32_16x16x32_bf16 v[32:35], v[52:55], v[76:79], v[32:35]
    v_mfma_f32_16x16x32_bf16 v[36:39], v[52:55], v[80:83], v[36:39]
    v_mfma_f32_16x16x32_bf16 v[40:43], v[52:55], v[84:87], v[40:43]
    v_mfma_f32_16x16x32_bf16 v[44:47], v[52:55], v[88:91], v[44:47]
    s_waitcnt lgkmcnt(8)
    v_mfma_f32_16x16x32_bf16 v[24:27], v[56:59], v[64:67], v[24:27]
    ds_read_b64 v[52:53], v1 offset:1152
    ds_read_b64 v[54:55], v1 offset:1160
    ds_read_b128 v[112:115], v2 offset:2048
    ds_read_b128 v[116:119], v2 offset:2560
    v_mfma_f32_16x16x32_bf16 v[28:31], v[56:59], v[68:71], v[28:31]
    v_mfma_f32_16x16x32_bf16 v[32:35], v[56:59], v[72:75], v[32:35]
    v_mfma_f32_16x16x32_bf16 v[36:39], v[56:59], v[76:79], v[36:39]
    v_mfma_f32_16x16x32_bf16 v[40:43], v[56:59], v[80:83], v[40:43]
    v_mfma_f32_16x16x32_bf16 v[44:47], v[56:59], v[84:87], v[44:47]
    s_waitcnt lgkmcnt(10)
    v_mfma_f32_16x16x32_bf16 v[28:31], v[60:63], v[64:67], v[28:31]
    ds_read_b64 v[56:57], v1 offset:640
    ds_read_b64 v[58:59], v1 offset:648
    ds_read_b128 v[120:123], v2 offset:3072
    ds_read_b128 v[124:127], v2 offset:3584
    v_mfma_f32_16x16x32_bf16 v[32:35], v[60:63], v[68:71], v[32:35]
    v_mfma_f32_16x16x32_bf16 v[36:39], v[60:63], v[72:75], v[36:39]
    v_mfma_f32_16x16x32_bf16 v[40:43], v[60:63], v[76:79], v[40:43]
    v_mfma_f32_16x16x32_bf16 v[44:47], v[60:63], v[80:83], v[44:47]
    s_waitcnt lgkmcnt(10)
    v_mfma_f32_16x16x32_bf16 v[32:35], v[48:51], v[64:67], v[32:35]
    ds_read_b64 v[60:61], v1 offset:128
    ds_read_b64 v[62:63], v1 offset:136
    v_mfma_f32_16x16x32_bf16 v[36:39], v[48:51], v[68:71], v[36:39]
    v_mfma_f32_16x16x32_bf16 v[40:43], v[48:51], v[72:75], v[40:43]
    v_mfma_f32_16x16x32_bf16 v[44:47], v[48:51], v[76:79], v[44:47]
    s_waitcnt lgkmcnt(8)
    v_mfma_f32_16x16x32_bf16 v[36:39], v[52:55], v[64:67], v[36:39]
    ds_read_b64 v[48:49], v1 offset:3584
    ds_read_b64 v[50:51], v1 offset:3592
    v_mfma_f32_16x16x32_bf16 v[40:43], v[52:55], v[68:71], v[40:43]
    v_mfma_f32_16x16x32_bf16 v[44:47], v[52:55], v[72:75], v[44:47]
    s_waitcnt lgkmcnt(6)
    v_mfma_f32_16x16x32_bf16 v[40:43], v[56:59], v[64:67], v[40:43]
    ds_read_b64 v[52:53], v1 offset:3072
    ds_read_b64 v[54:55], v1 offset:3080
    v_mfma_f32_16x16x32_bf16 v[44:47], v[56:59], v[68:71], v[44:47]
    s_waitcnt lgkmcnt(4)
    v_mfma_f32_16x16x32_bf16 v[44:47], v[60:63], v[64:67], v[44:47]
    ds_read_b64 v[56:57], v1 offset:2560
    ds_read_b64 v[58:59], v1 offset:2568
    s_waitcnt lgkmcnt(4)
    v_mfma_f32_16x16x32_bf16 v[16:19], v[48:51], v[96:99], v[16:19]
    ds_read_b64 v[60:61], v1 offset:2048
    ds_read_b64 v[62:63], v1 offset:2056
    v_mfma_f32_16x16x32_bf16 v[20:23], v[48:51], v[100:103], v[20:23]
    v_mfma_f32_16x16x32_bf16 v[24:27], v[48:51], v[104:107], v[24:27]
    v_mfma_f32_16x16x32_bf16 v[28:31], v[48:51], v[108:111], v[28:31]
    v_mfma_f32_16x16x32_bf16 v[32:35], v[48:51], v[112:115], v[32:35]
    v_mfma_f32_16x16x32_bf16 v[36:39], v[48:51], v[116:119], v[36:39]
    v_mfma_f32_16x16x32_bf16 v[40:43], v[48:51], v[120:123], v[40:43]
    v_mfma_f32_16x16x32_bf16 v[44:47], v[48:51], v[124:127], v[44:47]
    s_waitcnt lgkmcnt(4)
    v_mfma_f32_16x16x32_bf16 v[20:23], v[52:55], v[96:99], v[20:23]
    ds_read_b64 v[48:49], v1 offset:1536
    ds_read_b64 v[50:51], v1 offset:1544
    v_mfma_f32_16x16x32_bf16 v[24:27], v[52:55], v[100:103], v[24:27]
    v_mfma_f32_16x16x32_bf16 v[28:31], v[52:55], v[104:107], v[28:31]
    v_mfma_f32_16x16x32_bf16 v[32:35], v[52:55], v[108:111], v[32:35]
    v_mfma_f32_16x16x32_bf16 v[36:39], v[52:55], v[112:115], v[36:39]
    v_mfma_f32_16x16x32_bf16 v[40:43], v[52:55], v[116:119], v[40:43]
    v_mfma_f32_16x16x32_bf16 v[44:47], v[52:55], v[120:123], v[44:47]
    s_waitcnt lgkmcnt(4)
    v_mfma_f32_16x16x32_bf16 v[24:27], v[56:59], v[96:99], v[24:27]
    ds_read_b64 v[52:53], v1 offset:1024
    ds_read_b64 v[54:55], v1 offset:1032
    v_mfma_f32_16x16x32_bf16 v[28:31], v[56:59], v[100:103], v[28:31]
    v_mfma_f32_16x16x32_bf16 v[32:35], v[56:59], v[104:107], v[32:35]
    v_mfma_f32_16x16x32_bf16 v[36:39], v[56:59], v[108:111], v[36:39]
    v_mfma_f32_16x16x32_bf16 v[40:43], v[56:59], v[112:115], v[40:43]
    v_mfma_f32_16x16x32_bf16 v[44:47], v[56:59], v[116:119], v[44:47]
    s_waitcnt lgkmcnt(4)
    v_mfma_f32_16x16x32_bf16 v[28:31], v[60:63], v[96:99], v[28:31]
    ds_read_b64 v[56:57], v1 offset:512
    ds_read_b64 v[58:59], v1 offset:520
    v_mfma_f32_16x16x32_bf16 v[32:35], v[60:63], v[100:103], v[32:35]
    v_mfma_f32_16x16x32_bf16 v[36:39], v[60:63], v[104:107], v[36:39]
    v_mfma_f32_16x16x32_bf16 v[40:43], v[60:63], v[108:111], v[40:43]
    v_mfma_f32_16x16x32_bf16 v[44:47], v[60:63], v[112:115], v[44:47]
    s_waitcnt lgkmcnt(4)
    v_mfma_f32_16x16x32_bf16 v[32:35], v[48:51], v[96:99], v[32:35]
    ds_read_b64 v[60:61], v1 offset:0
    ds_read_b64 v[62:63], v1 offset:8
    v_mfma_f32_16x16x32_bf16 v[36:39], v[48:51], v[100:103], v[36:39]
    v_mfma_f32_16x16x32_bf16 v[40:43], v[48:51], v[104:107], v[40:43]
    v_mfma_f32_16x16x32_bf16 v[44:47], v[48:51], v[108:111], v[44:47]
    s_waitcnt lgkmcnt(4)
    v_mfma_f32_16x16x32_bf16 v[36:39], v[52:55], v[96:99], v[36:39]
    v_mfma_f32_16x16x32_bf16 v[40:43], v[52:55], v[100:103], v[40:43]
    v_mfma_f32_16x16x32_bf16 v[44:47], v[52:55], v[104:107], v[44:47]
    s_waitcnt lgkmcnt(2)
    v_mfma_f32_16x16x32_bf16 v[40:43], v[56:59], v[96:99], v[40:43]
    v_mfma_f32_16x16x32_bf16 v[44:47], v[56:59], v[100:103], v[44:47]
    s_waitcnt lgkmcnt(0)
    v_mfma_f32_16x16x32_bf16 v[44:47], v[60:63], v[96:99], v[44:47]
    s_cmp_eq_u32 s27, 1
    s_cbranch_scc1 S_epi1
    ds_read_b64 v[64:65], v4 offset:0
    ds_read_b64 v[66:67], v4 offset:1024
    ds_read_b64 v[68:69], v4 offset:2048
    ds_read_b64 v[70:71], v4 offset:3072
    s_nop 3
    ds_write_b128 v14, v[20:23] offset:0
    ds_write_b128 v14, v[28:31] offset:1024
    ds_write_b128 v14, v[36:39] offset:2048
    ds_write_b128 v14, v[44:47] offset:3072
    s_waitcnt lgkmcnt(4)
    v_lshlrev_b32 v96, 16, v64
    v_and_b32 v97, 0xffff0000, v64
    v_lshlrev_b32 v98, 16, v65
    v_and_b32 v99, 0xffff0000, v65
    v_fmac_f32 v16, s35, v96
    v_fmac_f32 v17, s35, v97
    v_fmac_f32 v18, s35, v98
    v_fmac_f32 v19, s35, v99
    v_lshlrev_b32 v100, 16, v66
    v_and_b32 v101, 0xffff0000, v66
    v_lshlrev_b32 v102, 16, v67
    v_and_b32 v103, 0xffff0000, v67
    v_fmac_f32 v24, s35, v100
    v_fmac_f32 v25, s35, v101
    v_fmac_f32 v26, s35, v102
    v_fmac_f32 v27, s35, v103
    v_lshlrev_b32 v104, 16, v68
    v_and_b32 v105, 0xffff0000, v68
    v_lshlrev_b32 v106, 16, v69
    v_and_b32 v107, 0xffff0000, v69
    v_fmac_f32 v32, s35, v104
    v_fmac_f32 v33, s35, v105
    v_fmac_f32 v34, s35, v106
    v_fmac_f32 v35, s35, v107
    v_lshlrev_b32 v108, 16, v70
    v_and_b32 v109, 0xffff0000, v70
    v_lshlrev_b32 v110, 16, v71
    v_and_b32 v111, 0xffff0000, v71
    v_fmac_f32 v40, s35, v108
    v_fmac_f32 v41, s35, v109
    v_fmac_f32 v42, s35, v110
    v_fmac_f32 v43, s35, v111
    s_waitcnt lgkmcnt(0)
    s_barrier
    ds_read_b128 v[80:83], v15 offset:0
    ds_read_b128 v[84:87], v15 offset:1024
    ds_read_b128 v[88:91], v15 offset:2048
    ds_read_b128 v[92:95], v15 offset:3072
    s_waitcnt lgkmcnt(3)
    v_add_f32 v16, v16, v80
    v_add_f32 v17, v17, v81
    v_add_f32 v18, v18, v82
    v_add_f32 v19, v19, v83
    v_cvt_pk_bf16_f32 v112, v16, v17
    v_cvt_pk_bf16_f32 v113, v18, v19
    s_waitcnt lgkmcnt(2)
    v_add_f32 v24, v24, v84
    v_add_f32 v25, v25, v85
    v_add_f32 v26, v26, v86
    v_add_f32 v27, v27, v87
    v_cvt_pk_bf16_f32 v114, v24, v25
    v_cvt_pk_bf16_f32 v115, v26, v27
    s_nop 1
    v_permlane16_swap_b32 v112, v114
    v_permlane16_swap_b32 v113, v115
    buffer_store_dwordx4 v[112:115], v3, s[16:19], s33 offen offset:0 sc1
    s_waitcnt lgkmcnt(1)
    v_add_f32 v32, v32, v88
    v_add_f32 v33, v33, v89
    v_add_f32 v34, v34, v90
    v_add_f32 v35, v35, v91
    v_cvt_pk_bf16_f32 v116, v32, v33
    v_cvt_pk_bf16_f32 v117, v34, v35
    s_waitcnt lgkmcnt(0)
    v_add_f32 v40, v40, v92
    v_add_f32 v41, v41, v93
    v_add_f32 v42, v42, v94
    v_add_f32 v43, v43, v95
    v_cvt_pk_bf16_f32 v118, v40, v41
    v_cvt_pk_bf16_f32 v119, v42, v43
    s_nop 1
    v_permlane16_swap_b32 v116, v118
    v_permlane16_swap_b32 v117, v119
    buffer_store_dwordx4 v[116:119], v3, s[16:19], s33 offen offset:2048 sc1
    s_branch S_done
S_epi1:
    ds_read_b64 v[64:65], v4 offset:512
    ds_read_b64 v[66:67], v4 offset:1536
    ds_read_b64 v[68:69], v4 offset:2560
    ds_read_b64 v[70:71], v4 offset:3584
    s_nop 3
    ds_write_b128 v14, v[16:19] offset:0
    ds_write_b128 v14, v[24:27] offset:1024
    ds_write_b128 v14, v[32:35] offset:2048
    ds_write_b128 v14, v[40:43] offset:3072
    s_waitcnt lgkmcnt(4)
    v_lshlrev_b32 v96, 16, v64
    v_and_b32 v97, 0xffff0000, v64
    v_lshlrev_b32 v98, 16, v65
    v_and_b32 v99, 0xffff0000, v65
    v_fmac_f32 v20, s35, v96
    v_fmac_f32 v21, s35, v97
    v_fmac_f32 v22, s35, v98
    v_fmac_f32 v23, s35, v99
    v_lshlrev_b32 v100, 16, v66
    v_and_b32 v101, 0xffff0000, v66
    v_lshlrev_b32 v102, 16, v67
    v_and_b32 v103, 0xffff0000, v67
    v_fmac_f32 v28, s35, v100
    v_fmac_f32 v29, s35, v101
    v_fmac_f32 v30, s35, v102
    v_fmac_f32 v31, s35, v103
    v_lshlrev_b32 v104, 16, v68
    v_and_b32 v105, 0xffff0000, v68
    v_lshlrev_b32 v106, 16, v69
    v_and_b32 v107, 0xffff0000, v69
    v_fmac_f32 v36, s35, v104
    v_fmac_f32 v37, s35, v105
    v_fmac_f32 v38, s35, v106
    v_fmac_f32 v39, s35, v107
    v_lshlrev_b32 v108, 16, v70
    v_and_b32 v109, 0xffff0000, v70
    v_lshlrev_b32 v110, 16, v71
    v_and_b32 v111, 0xffff0000, v71
    v_fmac_f32 v44, s35, v108
    v_fmac_f32 v45, s35, v109
    v_fmac_f32 v46, s35, v110
    v_fmac_f32 v47, s35, v111
    s_waitcnt lgkmcnt(0)
    s_barrier
    ds_read_b128 v[80:83], v15 offset:0
    ds_read_b128 v[84:87], v15 offset:1024
    ds_read_b128 v[88:91], v15 offset:2048
    ds_read_b128 v[92:95], v15 offset:3072
    s_waitcnt lgkmcnt(3)
    v_add_f32 v20, v20, v80
    v_add_f32 v21, v21, v81
    v_add_f32 v22, v22, v82
    v_add_f32 v23, v23, v83
    v_cvt_pk_bf16_f32 v112, v20, v21
    v_cvt_pk_bf16_f32 v113, v22, v23
    s_waitcnt lgkmcnt(2)
    v_add_f32 v28, v28, v84
    v_add_f32 v29, v29, v85
    v_add_f32 v30, v30, v86
    v_add_f32 v31, v31, v87
    v_cvt_pk_bf16_f32 v114, v28, v29
    v_cvt_pk_bf16_f32 v115, v30, v31
    s_nop 1
    v_permlane16_swap_b32 v112, v114
    v_permlane16_swap_b32 v113, v115
    buffer_store_dwordx4 v[112:115], v3, s[16:19], s33 offen offset:512 sc1
    s_waitcnt lgkmcnt(1)
    v_add_f32 v36, v36, v88
    v_add_f32 v37, v37, v89
    v_add_f32 v38, v38, v90
    v_add_f32 v39, v39, v91
    v_cvt_pk_bf16_f32 v116, v36, v37
    v_cvt_pk_bf16_f32 v117, v38, v39
    s_waitcnt lgkmcnt(0)
    v_add_f32 v44, v44, v92
    v_add_f32 v45, v45, v93
    v_add_f32 v46, v46, v94
    v_add_f32 v47, v47, v95
    v_cvt_pk_bf16_f32 v118, v44, v45
    v_cvt_pk_bf16_f32 v119, v46, v47
    s_nop 1
    v_permlane16_swap_b32 v116, v118
    v_permlane16_swap_b32 v117, v119
    buffer_store_dwordx4 v[116:119], v3, s[16:19], s33 offen offset:2560 sc1
S_done:
    s_lshl_b32 s38, s25, 2
    s_add_u32 s38, s38, s24
    s_lshl_b32 s38, s38, 3
    s_add_u32 s38, s38, 23552
    v_mov_b32 v10, s38
    v_mov_b32 v8, s96
    v_mov_b32 v9, s97
    s_mov_b64 exec, 1
    s_waitcnt vmcnt(0)
    buffer_store_dwordx2 v[8:9], v10, s[56:59], 0 offen sc1
    s_mov_b64 exec, -1
    s_endpgm
K_exit:
    s_endpgm
.section .rodata,"a"
.p2align 6
.amdhsa_kernel gated_mix__ssm_conv_s4__glu_gated_geglu__prompt_kernel
  .amdhsa_next_free_vgpr 256
  .amdhsa_next_free_sgpr 102
  .amdhsa_accum_offset 256
  .amdhsa_group_segment_fixed_size 0
  .amdhsa_kernarg_size 136
  .amdhsa_user_sgpr_count 2
  .amdhsa_user_sgpr_kernarg_segment_ptr 1
  .amdhsa_system_sgpr_workgroup_id_x 1
.end_amdhsa_kernel
```
